```python
import torch

def _softmax(x, axis=-1):
    return torch.softmax(x, dim=axis)
def _gelu(x):
    return torch.nn.functional.gelu(x, approximate="tanh")
def _silu(x):
    return torch.nn.functional.silu(x)
def _sigmoid(x):
    return torch.sigmoid(x)
def _layernorm(x, axis=-1, eps=1e-5):
    m = x.mean(dim=axis, keepdim=True)
    v = x.var(dim=axis, keepdim=True, unbiased=False)
    return (x - m) / torch.sqrt(v + eps)
def _scatter_add(tgt, idx, src, axis=0):
    return tgt.clone().index_add_(axis, idx, src)
def _segment_sum(src, seg, n):
    out = torch.zeros((n,) + src.shape[1:], dtype=src.dtype)
    return out.index_add_(0, seg, src)
def _pad(x, pw):
    flat = tuple(v for pair in reversed(pw) for v in pair)
    return torch.nn.functional.pad(x, flat)

kernel_name = 'gated_mix__grouped_kv_mqa__glu_gated_bilinear__prompt'

def setup_inputs():

    _w = (lambda a: (lambda t: t.to(torch.bfloat16) if t.is_floating_point() else t)(torch.as_tensor(a)))
    def _A_setup():
        B, S, D, H = 1, 2048, 512, 32
        Dh = D // H
        return {
            "x": _w((lambda *s: torch.randn(*s, dtype=torch.bfloat16) * 0.05)(B, S, D)),
            "wq": _w((lambda *s: torch.randn(*s, dtype=torch.bfloat16) * 0.8)(D, H * Dh)),
            "wk": _w((lambda *s: torch.randn(*s, dtype=torch.bfloat16) * 0.8)(D, Dh)),
            "wv": _w((lambda *s: torch.randn(*s, dtype=torch.bfloat16) * 0.05)(D, Dh)),
            "wo": _w((lambda *s: torch.randn(*s, dtype=torch.bfloat16) * 0.05)(H * Dh, D)),
        }
    _A_in = _A_setup()

    def _B_setup():
        B, S, D, F = 1, 2048, 512, 1792
        return {
            "x": _w((lambda *s: torch.randn(*s, dtype=torch.bfloat16) * 0.05)(B, S, D)),
            "w_gate": _w((lambda *s: torch.randn(*s, dtype=torch.bfloat16) * 0.8)(D, F) * (D ** -0.5)),
            "w_up": _w((lambda *s: torch.randn(*s, dtype=torch.bfloat16) * 0.8)(D, F) * (D ** -0.5)),
            "w_down": _w((lambda *s: torch.randn(*s, dtype=torch.bfloat16) * 0.8)(F, D) * (F ** -0.5)),
        }
    _B_in = _B_setup()

    return {
        "A_x": _A_in["x"],
        "A_wq": _A_in["wq"],
        "A_wk": _A_in["wk"],
        "A_wv": _A_in["wv"],
        "A_wo": _A_in["wo"],
        "B_x": _B_in["x"],
        "B_w_gate": _B_in["w_gate"],
        "B_w_up": _B_in["w_up"],
        "B_w_down": _B_in["w_down"],
        "gate_w": _w((lambda *s: torch.randn(*s, dtype=torch.bfloat16) * 0.05)(512) * 16.0),
    }

def reference(A_x, A_wq, A_wk, A_wv, A_wo, B_x, B_w_gate, B_w_up, B_w_down, gate_w):
    def _A_ref(x, wq, wk, wv, wo):
        B, S, D = x.shape
        H = 32
        Dh = D // H
        q = (lambda x, *d: x.permute(*d))((x @ wq).reshape(B, S, H, Dh), 0, 2, 1, 3)
        k = x @ wk
        v = x @ wv
        scores = torch.einsum("bhqd,bkd->bhqk", q, k) * (Dh ** -0.5)
        p = _softmax(scores, axis=-1)
        o = torch.einsum("bhqk,bkd->bhqd", p, v)
        return (lambda x, *d: x.permute(*d))(o, 0, 2, 1, 3).reshape(B, S, H * Dh) @ wo

    def _B_ref(x, w_gate, w_up, w_down):
        g = torch.einsum("bsd,df->bsf", x, w_gate)
        u = torch.einsum("bsd,df->bsf", x, w_up)
        h = g * u
        return torch.einsum("bsf,fd->bsd", h, w_down)

    x = A_x
    g = _sigmoid((x * gate_w).sum(-1, keepdims=True))
    a = _A_ref(x, A_wq, A_wk, A_wv, A_wo)
    b = _B_ref(x, B_w_gate, B_w_up, B_w_down)
    return g * a + (1 - g) * b
```

```asm
; @launch grid=(256,1,1) block=(768,1,1) lds=163840
.amdgcn_target "amdgcn-amd-amdhsa--gfx950"
.text
.globl gated_mix__grouped_kv_mqa__glu_gated_bilinear__prompt_kernel
.p2align 8
.type gated_mix__grouped_kv_mqa__glu_gated_bilinear__prompt_kernel,@function
gated_mix__grouped_kv_mqa__glu_gated_bilinear__prompt_kernel:
    s_cmp_ge_u32 s2, 256
    s_cbranch_scc1 L_exit
    s_load_dwordx8 s[4:11], s[0:1], 0
    s_load_dwordx2 s[12:13], s[0:1], 32
    s_load_dwordx8 s[16:23], s[0:1], 48
    s_load_dwordx4 s[24:27], s[0:1], 80
    s_load_dwordx2 s[28:29], s[0:1], 96
    s_getpc_b64 s[80:81]
L_pc_ref:
    s_mov_b32 s82, L_code_end-L_pc_ref
    s_mov_b32 s83, 0x00020000
    v_lshlrev_b32 v3, 7, v0
    buffer_load_dword v163, v3, s[80:83], 0 offen
    v_lshrrev_b32 v2, 6, v0
    v_and_b32 v1, 63, v0
    v_readfirstlane_b32 s30, v2
    s_and_b32 s14, s2, 7
    s_lshr_b32 s15, s2, 3
    s_and_b32 s31, s14, 1
    s_lshl_b32 s31, s31, 3
    s_and_b32 s32, s15, 7
    s_add_u32 s31, s31, s32
    s_lshr_b32 s32, s14, 1
    s_lshl_b32 s32, s32, 2
    s_lshr_b32 s35, s15, 3
    s_add_u32 s32, s32, s35
    s_lshl_b32 s33, s14, 2
    s_and_b32 s35, s15, 3
    s_add_u32 s33, s33, s35
    s_lshr_b32 s34, s15, 2
    s_andn2_b32 s3, 1, s32
    s_and_b32 s35, s32, 3
    s_lshl_b32 s35, s35, 3
    s_lshr_b32 s98, 0x16081000, s35
    s_and_b32 s98, s98, 0xff
    s_lshr_b32 s35, s32, 2
    s_mul_i32 s35, s35, 28
    s_add_u32 s98, s98, s35
    v_lshlrev_b32 v2, 4, v1
    v_mov_b32 v4, 162368
    v_mov_b32 v6, 0
    v_mov_b32 v7, 0
    ds_write_b64 v4, v[6:7]
    ds_write_b32 v4, v6 offset:8
    s_mov_b32 s38, 2097152
    s_mov_b32 s39, 0x00020000
    s_mov_b32 s42, 268435456
    s_mov_b32 s43, 0x00020000
    s_cmp_lt_u32 s30, 8
    s_cbranch_scc1 L_role_c
    s_setprio 3
    s_sub_u32 s44, s30, 8
    s_lshl_b32 s45, s44, 10
    s_mul_i32 s76, s44, 9472
    s_add_u32 s76, s76, 106496
    s_lshl_b32 s77, s31, 3
    s_lshr_b32 s14, s32, 1
    s_add_u32 s77, s77, s14
    s_mov_b32 s78, 0xffff
    s_mov_b32 s79, 0xffff
    s_mov_b32 s50, 1835008
    s_mov_b32 s51, 0x00020000
    s_mov_b32 s54, 1835008
    s_mov_b32 s55, 0x00020000
    s_mov_b32 s58, 1835008
    s_mov_b32 s59, 0x00020000
    s_mov_b32 s62, 1835008
    s_mov_b32 s63, 0x00020000
    v_lshrrev_b32 v4, 2, v1
    v_lshrrev_b32 v5, 4, v1
    v_and_b32 v10, 3, v1
    v_xor_b32 v10, v10, v5
    v_lshlrev_b32 v10, 4, v10
    v_lshl_add_u32 v10, v4, 10, v10
    s_lshl_b32 s14, s31, 7
    s_lshl_b32 s15, s44, 4
    s_add_u32 s14, s14, s15
    s_lshl_b32 s14, s14, 10
    v_add_u32 v10, s14, v10
    v_add_u32 v11, 0x10000, v10
    s_lshl_b32 s46, s98, 5
    s_mov_b32 s86, 524288
    s_mov_b32 s87, 0x00020000
    v_lshlrev_b32 v14, 10, v4
    v_and_b32 v15, 3, v1
    v_lshl_add_u32 v14, v15, 4, v14
    s_lshl_b32 s14, s32, 6
    s_lshl_b32 s15, s44, 13
    s_add_u32 s14, s14, s15
    v_add_u32 v14, s14, v14
    s_lshl_b32 s66, s44, 9
    s_add_u32 s66, s66, 16384
    s_mov_b32 s88, -1
    s_mov_b32 s89, 0
    s_cmp_eq_u32 s3, 0
    s_cbranch_scc1 L_g_tB
    s_mov_b32 s71, 0
    v_and_b32 v8, 15, v1
    v_lshlrev_b32 v4, 2, v5
    v_xor_b32 v8, v8, v4
    v_lshlrev_b32 v8, 4, v8
    s_lshl_b32 s14, s44, 2
    v_add_u32 v4, s14, v5
    v_mul_u32_u24 v4, 3584, v4
    v_add3_u32 v8, v8, v4, s46
    v_xor_b32 v9, 32, v8
    v_add_u32 v12, 57344, v8
    v_add_u32 v13, 57344, v9
    s_add_u32 s47, s45, 8192
    s_add_u32 s64, s45, 4096
    s_add_u32 s65, s45, 12288
    s_mov_b64 s[74:75], -1
    s_branch L_g_qdone
L_g_tB:
    s_lshl_b32 s14, s44, 6
    v_add_u32 v8, s14, v1
    v_mul_u32_u24 v4, 5462, v8
    v_lshrrev_b32 v4, 16, v4
    v_lshlrev_b32 v8, 4, v8
    v_mul_u32_u24 v4, 3392, v4
    v_add3_u32 v8, v8, v4, s46
    v_mov_b32 v9, v8
    s_and_b32 s47, s44, 1
    s_add_u32 s47, s47, 4
    s_lshl_b32 s14, s47, 6
    v_add_u32 v12, s14, v1
    v_mul_u32_u24 v4, 5462, v12
    v_lshrrev_b32 v4, 16, v4
    v_lshlrev_b32 v12, 4, v12
    v_mul_u32_u24 v4, 3392, v4
    v_add3_u32 v12, v12, v4, s46
    v_mov_b32 v13, v8
    s_lshl_b32 s64, s47, 10
    s_cmp_lt_u32 s44, 2
    s_cselect_b32 s71, 0, 6176
    s_add_u32 s64, s64, s71
    s_add_u32 s47, s45, 6176
    s_mov_b32 s65, s45
    s_mov_b64 s[74:75], 1
L_g_qdone:
    s_mov_b32 s67, 0
    s_mov_b32 s68, 0
    s_mov_b32 s69, 0
    s_mov_b32 s70, 0
    s_getpc_b64 s[72:73]
L_g_ref:
    s_add_u32 s72, s72, L_g_after-L_g_ref
    s_addc_u32 s73, s73, 0
    s_waitcnt lgkmcnt(0)
    s_mov_b64 s[36:37], s[4:5]
    s_mov_b64 s[48:49], s[16:17]
    s_mov_b64 s[52:53], s[18:19]
    s_mov_b64 s[84:85], s[6:7]
    s_cmp_eq_u32 s71, 0
    s_cselect_b64 s[56:57], s[16:17], s[18:19]
    s_cmp_eq_u32 s3, 0
    s_cselect_b64 s[60:61], s[16:17], s[18:19]
L_g_issue:
    s_add_u32 s14, s45, s70
    s_add_u32 m0, s14, 18432
    s_nop 0
    buffer_load_dwordx4 v10, s[36:39], s69 offen lds
    s_add_u32 m0, s14, 22528
    s_nop 0
    buffer_load_dwordx4 v11, s[36:39], s69 offen lds
    s_mov_b32 m0, s14
    s_add_u32 s69, s69, 64
    buffer_load_dwordx4 v8, s[48:51], s67 offen lds
    s_add_u32 m0, s47, s70
    s_nop 0
    buffer_load_dwordx4 v9, s[52:55], s67 offen lds
    s_add_u32 m0, s64, s70
    s_nop 0
    buffer_load_dwordx4 v12, s[56:59], s67 offen lds
    s_add_u32 m0, s65, s70
    s_mov_b64 exec, s[74:75]
    buffer_load_dwordx4 v13, s[60:63], s67 offen lds
    s_add_u32 m0, s66, s70
    s_mov_b64 exec, s[88:89]
    buffer_load_dwordx4 v14, s[84:87], s68 offen lds
    s_mov_b64 exec, -1
    s_add_u32 s67, s67, 114688
    s_add_u32 s68, s68, 32768
    s_add_u32 s70, s70, 26624
    s_cmp_eq_u32 s70, 133120
    s_cselect_b32 s70, 0, s70
    s_setpc_b64 s[72:73]
L_g_after:
    s_mov_b64 s[40:41], s[28:29]
    s_cmp_lg_u32 s3, 0
    s_cbranch_scc1 L_g_noA1
    s_mov_b32 s80, s8
    s_mov_b32 s81, s9
    s_mov_b32 s82, 16384
    s_mov_b32 s83, 0x00020000
    s_lshl_b32 s14, s44, 12
    s_mov_b32 m0, s76
    v_and_b32 v7, 31, v1
    buffer_load_dwordx4 v2, s[80:83], s14 offen offset:0 lds
    buffer_load_dwordx4 v2, s[80:83], s14 offen offset:1024 lds
    buffer_load_dwordx4 v2, s[80:83], s14 offen offset:2048 lds
    buffer_load_dwordx4 v2, s[80:83], s14 offen offset:3072 lds
    s_mov_b32 s80, s10
    s_mov_b32 s81, s11
    s_mov_b32 s82, 16384
    s_mov_b32 s83, 0x00020000
    s_add_u32 m0, s76, 4224
    v_lshlrev_b32 v7, 10, v7
    buffer_load_dwordx4 v2, s[80:83], s14 offen offset:0 lds
    buffer_load_dwordx4 v2, s[80:83], s14 offen offset:1024 lds
    buffer_load_dwordx4 v2, s[80:83], s14 offen offset:2048 lds
    buffer_load_dwordx4 v2, s[80:83], s14 offen offset:3072 lds
    s_mov_b32 s80, s22
    s_mov_b32 s81, s23
    s_mov_b32 s82, 1024
    s_mov_b32 s83, 0x00020000
    s_add_u32 m0, s76, 8448
    s_lshl_b32 s14, s77, 14
    buffer_load_dwordx4 v2, s[80:83], 0 offen lds
    s_lshl_b32 s15, s44, 8
    s_add_u32 s14, s14, s15
    v_lshrrev_b32 v6, 5, v1
    v_lshl_add_u32 v7, v6, 4, v7
    s_mov_b64 exec, s[78:79]
    buffer_load_dwordx4 v[96:99], v7, s[36:39], s14 offen offset:0
    buffer_load_dwordx4 v[100:103], v7, s[36:39], s14 offen offset:32
    buffer_load_dwordx4 v[104:107], v7, s[36:39], s14 offen offset:64
    buffer_load_dwordx4 v[108:111], v7, s[36:39], s14 offen offset:96
    buffer_load_dwordx4 v[112:115], v7, s[36:39], s14 offen offset:128
    buffer_load_dwordx4 v[116:119], v7, s[36:39], s14 offen offset:160
    buffer_load_dwordx4 v[120:123], v7, s[36:39], s14 offen offset:192
    buffer_load_dwordx4 v[124:127], v7, s[36:39], s14 offen offset:224
    s_mov_b64 exec, -1
    s_call_b64 s[72:73], L_g_issue
    s_barrier
    s_waitcnt vmcnt(24)
    s_branch L_g_start
L_g_noA1:
    s_call_b64 s[72:73], L_g_issue
    s_barrier
    s_waitcnt vmcnt(7)
L_g_start:
    s_barrier
    s_call_b64 s[72:73], L_g_issue
    s_cmp_eq_u32 s3, 0
    s_cbranch_scc1 L_g_ev_pa
L_g_r0:
    s_waitcnt vmcnt(7) lgkmcnt(0)
    s_barrier
    s_call_b64 s[72:73], L_g_issue
    s_cmp_eq_u32 s3, 0
    s_cbranch_scc1 L_g_ev_red
L_g_r1:
    s_waitcnt vmcnt(7) lgkmcnt(0)
    s_barrier
    s_call_b64 s[72:73], L_g_issue
    s_waitcnt vmcnt(7)
    s_barrier
    s_or_b32 s71, s3, s44
    s_cmp_lg_u32 s71, 0
    s_cbranch_scc1 L_g_nsig
    s_and_b32 s71, s2, 1
    s_lshl_b32 s71, s71, 7
    v_mov_b32 v6, s71
    v_mov_b32 v7, 1
    s_mov_b64 exec, 1
    global_atomic_add v6, v7, s[26:27] sc1
    s_mov_b64 exec, -1
L_g_nsig:
    s_call_b64 s[72:73], L_g_issue
    s_call_b64 s[72:73], L_g_issue
    s_waitcnt vmcnt(14)
    s_barrier
    s_call_b64 s[72:73], L_g_issue
    s_mov_b32 s71, 8
L_g_loop:
    s_call_b64 s[72:73], L_g_issue
    s_add_u32 s71, s71, 1
    s_cmp_eq_u32 s71, 16
    s_cbranch_scc1 L_g_tail
    s_waitcnt vmcnt(21)
    s_barrier
    s_branch L_g_loop
L_g_ev_pa:
    v_lshrrev_b32 v3, 4, v1
    v_bfe_u32 v4, v1, 2, 2
    v_and_b32 v6, 1, v1
    v_lshlrev_b32 v5, 4, v6
    v_bfe_u32 v6, v1, 1, 1
    v_lshl_or_b32 v5, v6, 3, v5
    v_lshrrev_b32 v6, 1, v3
    v_lshl_add_u32 v4, v6, 3, v4
    v_and_b32 v3, 1, v3
    v_mul_u32_u24 v6, 4224, v3
    v_lshl_add_u32 v6, v4, 5, v6
    v_add3_u32 v6, v6, v5, s76
    v_lshrrev_b32 v7, 5, v1
    v_lshlrev_b32 v7, 4, v7
    s_lshl_b32 s14, s44, 8
    s_add_u32 s14, s14, s76
    v_add_u32 v7, s14, v7
    s_waitcnt vmcnt(14)
    ds_read_b64_tr_b16 v[128:129], v6 offset:0
    ds_read_b64_tr_b16 v[130:131], v6 offset:128
    ds_read_b64_tr_b16 v[132:133], v6 offset:512
    ds_read_b64_tr_b16 v[134:135], v6 offset:640
    ds_read_b64_tr_b16 v[136:137], v6 offset:1024
    ds_read_b64_tr_b16 v[138:139], v6 offset:1152
    ds_read_b64_tr_b16 v[140:141], v6 offset:1536
    ds_read_b64_tr_b16 v[142:143], v6 offset:1664
    s_waitcnt lgkmcnt(0)
    ds_read_b64_tr_b16 v[144:145], v6 offset:2048
    ds_read_b64_tr_b16 v[146:147], v6 offset:2176
    ds_read_b64_tr_b16 v[148:149], v6 offset:2560
    ds_read_b64_tr_b16 v[150:151], v6 offset:2688
    ds_read_b64_tr_b16 v[152:153], v6 offset:3072
    ds_read_b64_tr_b16 v[154:155], v6 offset:3200
    ds_read_b64_tr_b16 v[156:157], v6 offset:3584
    ds_read_b64_tr_b16 v[158:159], v6 offset:3712
    s_waitcnt lgkmcnt(0)
    ds_read_b128 v[16:19], v7 offset:8448
    ds_read_b128 v[20:23], v7 offset:8480
    ds_read_b128 v[24:27], v7 offset:8512
    ds_read_b128 v[28:31], v7 offset:8544
    ds_read_b128 v[32:35], v7 offset:8576
    ds_read_b128 v[36:39], v7 offset:8608
    ds_read_b128 v[40:43], v7 offset:8640
    ds_read_b128 v[44:47], v7 offset:8672
    v_mfma_f32_32x32x16_bf16 v[64:79], v[128:131], v[96:99], 0
    v_mfma_f32_32x32x16_bf16 v[64:79], v[132:135], v[100:103], v[64:79]
    v_mfma_f32_32x32x16_bf16 v[64:79], v[136:139], v[104:107], v[64:79]
    v_mfma_f32_32x32x16_bf16 v[64:79], v[140:143], v[108:111], v[64:79]
    v_mfma_f32_32x32x16_bf16 v[64:79], v[144:147], v[112:115], v[64:79]
    v_mfma_f32_32x32x16_bf16 v[64:79], v[148:151], v[116:119], v[64:79]
    v_mfma_f32_32x32x16_bf16 v[64:79], v[152:155], v[120:123], v[64:79]
    v_mfma_f32_32x32x16_bf16 v[64:79], v[156:159], v[124:127], v[64:79]
    s_waitcnt lgkmcnt(0)
    v_mfma_f32_32x32x16_bf16 v[80:95], v[16:19], v[96:99], 0
    v_mfma_f32_32x32x16_bf16 v[80:95], v[20:23], v[100:103], v[80:95]
    v_mfma_f32_32x32x16_bf16 v[80:95], v[24:27], v[104:107], v[80:95]
    v_mfma_f32_32x32x16_bf16 v[80:95], v[28:31], v[108:111], v[80:95]
    v_mfma_f32_32x32x16_bf16 v[80:95], v[32:35], v[112:115], v[80:95]
    v_mfma_f32_32x32x16_bf16 v[80:95], v[36:39], v[116:119], v[80:95]
    v_mfma_f32_32x32x16_bf16 v[80:95], v[40:43], v[120:123], v[80:95]
    v_mfma_f32_32x32x16_bf16 v[80:95], v[44:47], v[124:127], v[80:95]
    v_and_b32 v6, 31, v1
    v_lshrrev_b32 v60, 5, v1
    v_lshl_add_u32 v61, v6, 1, v60
    v_lshlrev_b32 v61, 5, v61
    v_add_u32 v7, s76, v61
    v_lshlrev_b32 v60, 10, v60
    v_lshl_add_u32 v60, v6, 2, v60
    v_add_u32 v60, s76, v60
    v_lshlrev_b32 v6, 2, v6
    v_add_u32 v5, s76, v6
    ds_write_b128 v7, v[64:67]
    ds_write_b128 v7, v[68:71] offset:16
    ds_write_b32 v60, v72 offset:2048
    ds_write_b32 v60, v73 offset:2176
    ds_write_b32 v60, v74 offset:2304
    ds_write_b32 v60, v75 offset:2432
    ds_write_b32 v60, v76 offset:2560
    ds_write_b32 v60, v77 offset:2688
    ds_write_b32 v60, v78 offset:2816
    ds_write_b32 v60, v79 offset:2944
    s_nop 3
    ds_write_b32 v5, v80 offset:4096
    s_branch L_g_r0
L_g_ev_red:
    s_cmp_eq_u32 s44, 3
    s_cbranch_scc1 L_g_r1
    s_cmp_eq_u32 s44, 2
    s_cbranch_scc1 L_g_pa_z
    s_lshr_b32 s14, s77, 1
    s_lshl_b32 s14, s14, 10
    s_and_b32 s15, s77, 1
    s_lshl_b32 s15, s15, 8
    s_add_u32 s14, s14, s15
    v_and_b32 v6, 31, v1
    v_lshrrev_b32 v60, 5, v1
    v_lshl_add_u32 v61, v6, 1, v60
    v_lshlrev_b32 v61, 5, v61
    s_cmp_eq_u32 s44, 0
    s_cbranch_scc1 L_g_pa_red
    s_add_u32 s14, s14, s15
    s_mov_b32 s78, -1
    s_mov_b32 s79, 0
    v_bfe_u32 v60, v1, 2, 1
    v_lshlrev_b32 v60, 3, v60
    v_bfe_u32 v61, v1, 3, 1
    v_lshl_add_u32 v60, v61, 2, v60
    v_and_b32 v61, 3, v1
    v_add_u32 v60, v60, v61
    v_lshlrev_b32 v60, 7, v60
    v_lshrrev_b32 v61, 4, v1
    v_lshl_add_u32 v61, v61, 5, v60
    v_add_u32 v61, 2048, v61
    s_add_u32 s14, s14, 65536
L_g_pa_red:
    v_add_u32 v61, 106496, v61
    ds_read_b128 v[64:67], v61 offset:0
    ds_read_b128 v[68:71], v61 offset:16
    ds_read_b128 v[72:75], v61 offset:9472
    ds_read_b128 v[76:79], v61 offset:9488
    ds_read_b128 v[80:83], v61 offset:18944
    ds_read_b128 v[84:87], v61 offset:18960
    ds_read_b128 v[88:91], v61 offset:28416
    ds_read_b128 v[92:95], v61 offset:28432
    s_waitcnt lgkmcnt(0)
    v_pk_add_f32 v[64:65], v[64:65], v[80:81]
    v_pk_add_f32 v[66:67], v[66:67], v[82:83]
    v_pk_add_f32 v[68:69], v[68:69], v[84:85]
    v_pk_add_f32 v[70:71], v[70:71], v[86:87]
    v_pk_add_f32 v[72:73], v[72:73], v[88:89]
    v_pk_add_f32 v[74:75], v[74:75], v[90:91]
    v_pk_add_f32 v[76:77], v[76:77], v[92:93]
    v_pk_add_f32 v[78:79], v[78:79], v[94:95]
    v_pk_add_f32 v[64:65], v[64:65], v[72:73]
    v_pk_add_f32 v[66:67], v[66:67], v[74:75]
    v_pk_add_f32 v[68:69], v[68:69], v[76:77]
    v_pk_add_f32 v[70:71], v[70:71], v[78:79]
    v_cvt_pk_bf16_f32 v140, v64, v65
    v_cvt_pk_bf16_f32 v141, v66, v67
    v_cvt_pk_bf16_f32 v142, v68, v69
    v_cvt_pk_bf16_f32 v143, v70, v71
    s_mov_b64 exec, s[78:79]
    buffer_store_dwordx4 v[140:143], v2, s[40:43], s14 offen sc1
    s_mov_b64 exec, -1
    s_branch L_g_r1
L_g_pa_z:
    v_and_b32 v6, 15, v1
    v_lshlrev_b32 v6, 2, v6
    v_add_u32 v60, 106496, v6
    ds_read_b32 v64, v60 offset:4096
    ds_read_b32 v65, v60 offset:13568
    ds_read_b32 v66, v60 offset:23040
    ds_read_b32 v67, v60 offset:32512
    s_cmp_lg_u32 s32, 1
    s_cbranch_scc1 L_g_nofl
    v_mov_b32 v7, 0
    s_lshl_b32 s14, s31, 7
    s_add_u32 s14, s14, 196608
    buffer_store_dword v7, v7, s[40:43], s14 offen sc1
L_g_nofl:
    s_waitcnt lgkmcnt(0)
    v_add_f32 v64, v64, v65
    v_add_f32 v64, v64, v66
    v_add_f32 v64, v64, v67
    v_mul_f32 v64, 0xbfb8aa3b, v64
    v_exp_f32 v64, v64
    s_lshl_b32 s14, s77, 6
    v_add_f32 v64, 1.0, v64
    v_rcp_f32 v140, v64
    s_add_u32 s14, s14, 131072
    buffer_store_dword v140, v6, s[40:43], s14 offen sc1
    s_branch L_g_r1
L_g_tail:
    s_waitcnt vmcnt(21)
    s_barrier
    s_add_u32 s14, s45, 26624
    s_mov_b32 m0, s14
    s_nop 0
    buffer_load_dwordx4 v2, s[40:43], s14 offen sc1 lds
    s_add_u32 s14, s45, 30720
    s_mov_b32 m0, s14
    s_nop 0
    buffer_load_dwordx4 v2, s[40:43], s14 offen sc1 lds
    s_add_u32 s14, s45, 34816
    s_mov_b32 m0, s14
    s_nop 0
    buffer_load_dwordx4 v2, s[40:43], s14 offen sc1 lds
    s_add_u32 s14, s45, 38912
    s_mov_b32 m0, s14
    s_nop 0
    buffer_load_dwordx4 v2, s[40:43], s14 offen sc1 lds
    s_add_u32 s14, s45, 43008
    s_mov_b32 m0, s14
    s_nop 0
    buffer_load_dwordx4 v2, s[40:43], s14 offen sc1 lds
    s_add_u32 s14, s45, 47104
    s_mov_b32 m0, s14
    s_nop 0
    buffer_load_dwordx4 v2, s[40:43], s14 offen sc1 lds
    s_mov_b32 s14, 51200
    s_cmp_eq_u32 s44, 1
    s_cselect_b32 s14, 52224, s14
    s_cmp_eq_u32 s44, 2
    s_cselect_b32 s14, 52224, s14
    s_cmp_eq_u32 s44, 3
    s_cselect_b32 s14, 52224, s14
    s_mov_b32 m0, s14
    s_nop 0
    buffer_load_dwordx4 v2, s[40:43], s14 offen sc1 lds
    s_waitcnt vmcnt(21)
    s_barrier
    s_add_u32 s14, s45, 53248
    s_mov_b32 m0, s14
    s_nop 0
    buffer_load_dwordx4 v2, s[40:43], s14 offen sc1 lds
    s_add_u32 s14, s45, 57344
    s_mov_b32 m0, s14
    s_nop 0
    buffer_load_dwordx4 v2, s[40:43], s14 offen sc1 lds
    s_add_u32 s14, s45, 61440
    s_mov_b32 m0, s14
    s_nop 0
    buffer_load_dwordx4 v2, s[40:43], s14 offen sc1 lds
    s_add_u32 s14, s45, 65536
    s_mov_b32 m0, s14
    s_nop 0
    buffer_load_dwordx4 v2, s[40:43], s14 offen sc1 lds
    s_add_u32 s14, s45, 69632
    s_mov_b32 m0, s14
    s_nop 0
    buffer_load_dwordx4 v2, s[40:43], s14 offen sc1 lds
    s_add_u32 s14, s45, 73728
    s_mov_b32 m0, s14
    s_nop 0
    buffer_load_dwordx4 v2, s[40:43], s14 offen sc1 lds
    s_mov_b32 s14, 77824
    s_cmp_eq_u32 s44, 1
    s_cselect_b32 s14, 78848, s14
    s_cmp_eq_u32 s44, 2
    s_cselect_b32 s14, 78848, s14
    s_cmp_eq_u32 s44, 3
    s_cselect_b32 s14, 78848, s14
    s_mov_b32 m0, s14
    s_nop 0
    buffer_load_dwordx4 v2, s[40:43], s14 offen sc1 lds
    s_waitcnt vmcnt(21)
    s_barrier
    s_add_u32 s14, s45, 79872
    s_mov_b32 m0, s14
    s_nop 0
    buffer_load_dwordx4 v2, s[40:43], s14 offen sc1 lds
    s_add_u32 s14, s45, 83968
    s_mov_b32 m0, s14
    s_nop 0
    buffer_load_dwordx4 v2, s[40:43], s14 offen sc1 lds
    s_add_u32 s14, s45, 88064
    s_mov_b32 m0, s14
    s_nop 0
    buffer_load_dwordx4 v2, s[40:43], s14 offen sc1 lds
    s_add_u32 s14, s45, 92160
    s_mov_b32 m0, s14
    s_nop 0
    buffer_load_dwordx4 v2, s[40:43], s14 offen sc1 lds
    s_add_u32 s14, s45, 96256
    s_mov_b32 m0, s14
    s_nop 0
    buffer_load_dwordx4 v2, s[40:43], s14 offen sc1 lds
    s_add_u32 s14, s45, 100352
    s_mov_b32 m0, s14
    s_nop 0
    buffer_load_dwordx4 v2, s[40:43], s14 offen sc1 lds
    s_mov_b32 s14, 104448
    s_cmp_eq_u32 s44, 1
    s_cselect_b32 s14, 105472, s14
    s_cmp_eq_u32 s44, 2
    s_cselect_b32 s14, 105472, s14
    s_cmp_eq_u32 s44, 3
    s_cselect_b32 s14, 105472, s14
    s_mov_b32 m0, s14
    s_nop 0
    buffer_load_dwordx4 v2, s[40:43], s14 offen sc1 lds
    s_waitcnt vmcnt(21)
    s_barrier
    s_add_u32 s14, s45, 106496
    s_mov_b32 m0, s14
    s_nop 0
    buffer_load_dwordx4 v2, s[40:43], s14 offen sc1 lds
    s_add_u32 s14, s45, 110592
    s_mov_b32 m0, s14
    s_nop 0
    buffer_load_dwordx4 v2, s[40:43], s14 offen sc1 lds
    s_add_u32 s14, s45, 114688
    s_mov_b32 m0, s14
    s_nop 0
    buffer_load_dwordx4 v2, s[40:43], s14 offen sc1 lds
    s_add_u32 s14, s45, 118784
    s_mov_b32 m0, s14
    s_nop 0
    buffer_load_dwordx4 v2, s[40:43], s14 offen sc1 lds
    s_add_u32 s14, s45, 122880
    s_mov_b32 m0, s14
    s_nop 0
    buffer_load_dwordx4 v2, s[40:43], s14 offen sc1 lds
    s_add_u32 s14, s45, 126976
    s_mov_b32 m0, s14
    s_nop 0
    buffer_load_dwordx4 v2, s[40:43], s14 offen sc1 lds
    s_barrier
    s_add_u32 s14, s45, 0
    s_mov_b32 m0, s14
    s_nop 0
    buffer_load_dwordx4 v2, s[40:43], s14 offen sc1 lds
    s_add_u32 s14, s45, 4096
    s_mov_b32 m0, s14
    s_nop 0
    buffer_load_dwordx4 v2, s[40:43], s14 offen sc1 lds
    s_add_u32 s14, s45, 8192
    s_mov_b32 m0, s14
    s_nop 0
    buffer_load_dwordx4 v2, s[40:43], s14 offen sc1 lds
    s_add_u32 s14, s45, 12288
    s_mov_b32 m0, s14
    s_nop 0
    buffer_load_dwordx4 v2, s[40:43], s14 offen sc1 lds
    s_add_u32 s14, s45, 16384
    s_mov_b32 m0, s14
    s_nop 0
    buffer_load_dwordx4 v2, s[40:43], s14 offen sc1 lds
    s_add_u32 s14, s45, 20480
    s_mov_b32 m0, s14
    s_nop 0
    buffer_load_dwordx4 v2, s[40:43], s14 offen sc1 lds
    s_mov_b32 s14, 24576
    s_cmp_eq_u32 s44, 1
    s_cselect_b32 s14, 25600, s14
    s_cmp_eq_u32 s44, 2
    s_cselect_b32 s14, 25600, s14
    s_cmp_eq_u32 s44, 3
    s_cselect_b32 s14, 25600, s14
    s_mov_b32 m0, s14
    s_nop 0
    buffer_load_dwordx4 v2, s[40:43], s14 offen sc1 lds
    v_cmp_gt_u32 vcc, 4, v1
    v_lshlrev_b32 v3, 2, v1
    v_add_u32 v3, 162304, v3
    v_cndmask_b32_e64 v4, 0, 2, vcc
    s_mov_b64 exec, 0xffff
    ds_write_b32 v3, v4
    s_mov_b64 exec, -1
    s_waitcnt vmcnt(7) lgkmcnt(0)
    s_barrier
    v_mov_b32 v3, 162364
    v_mov_b32 v4, 1
    s_waitcnt vmcnt(0)
    s_mov_b64 exec, 1
    ds_add_u32 v3, v4
    s_mov_b64 exec, -1
    s_branch L_g2
L_role_c:
    s_waitcnt lgkmcnt(0)
    s_mov_b64 s[36:37], s[4:5]
    s_mov_b64 s[40:41], s[28:29]
    v_mov_b32 v158, s4
    v_mov_b32 v159, s5
    v_mov_b32 v157, 0
    s_add_u32 s47, s30, 1
    s_cmp_eq_u32 s3, 0
    s_cbranch_scc1 L_c_pfB
    s_cmp_ge_u32 s30, 7
    s_cbranch_scc1 L_c_latepf
    s_branch L_c_pfgo
L_c_pfB:
    s_mov_b32 s47, 7
    s_cmp_lg_u32 s30, 7
    s_cbranch_scc1 L_c_latepf
L_c_pfgo:
    s_lshr_b32 s44, s2, 3
    s_lshr_b32 s45, s2, 7
    s_and_b32 s44, s44, 7
    s_lshl_b32 s45, s45, 3
    s_add_u32 s44, s44, s45
    s_and_b32 s45, s2, 7
    s_lshr_b32 s46, s45, 1
    s_lshl_b32 s47, s47, 6
    s_add_u32 s47, s47, s44
    v_lshrrev_b32 v3, 4, v1
    v_lshl_add_u32 v3, v3, 4, s47
    v_and_b32 v4, 15, v1
    s_mul_i32 s48, s46, 896
    v_mul_u32_u24 v5, 3584, v3
    v_lshl_add_u32 v5, v4, 7, v5
    v_add_u32 v5, s48, v5
    v_mov_b32 v6, s16
    v_mov_b32 v7, s17
    v_cmp_lt_u32 vcc, 6, v4
    v_mov_b32 v8, s18
    v_mov_b32 v9, s19
    v_subrev_u32 v10, 896, v5
    v_cndmask_b32 v6, v6, v8, vcc
    v_cndmask_b32 v7, v7, v9, vcc
    v_cndmask_b32 v5, v5, v10, vcc
    v_cmp_lt_u32 vcc, 13, v4
    v_mov_b32 v8, s6
    v_mov_b32 v9, s7
    v_lshlrev_b32 v10, 10, v3
    v_and_b32 v11, 1, v1
    v_lshl_add_u32 v10, v11, 7, v10
    s_lshl_b32 s48, s46, 8
    v_add_u32 v10, s48, v10
    v_cndmask_b32 v6, v6, v8, vcc
    v_cndmask_b32 v7, v7, v9, vcc
    v_cndmask_b32 v5, v5, v10, vcc
    v_mov_b32 v157, 229376
    v_mov_b32 v10, 65536
    v_cndmask_b32 v157, v157, v10, vcc
    v_add_co_u32 v158, vcc, v6, v5
    s_nop 1
    v_addc_co_u32 v159, vcc, 0, v7, vcc
    s_cmp_eq_u32 s3, 0
    s_cbranch_scc1 L_c_latepf
    s_barrier
    global_load_dword v160, v[158:159], off
    s_branch L_c_pfend
L_c_latepf:
    s_barrier
L_c_pfend:
    s_and_b32 s70, s30, 3
    s_lshr_b32 s71, s30, 2
    s_lshl_b32 s72, s31, 2
    s_add_u32 s72, s72, s70
    s_mul_i32 s78, s72, 144
    s_lshl_b32 s73, s32, 1
    s_add_u32 s78, s78, s73
    s_add_u32 s78, s78, 112
    s_lshl_b32 s78, s78, 10
    s_add_u32 s78, s78, 4194304
    s_lshl_b32 s73, s71, 10
    s_add_u32 s73, s73, s78
    v_mov_b32 v8, -1
    v_mov_b32 v9, -1
    v_mov_b32 v10, -1
    v_mov_b32 v11, -1
    buffer_store_dwordx4 v[8:11], v2, s[40:43], s73 offen sc1
    v_lshrrev_b32 v3, 4, v1
    v_bfe_u32 v4, v1, 2, 2
    v_and_b32 v6, 1, v1
    v_lshlrev_b32 v5, 4, v6
    v_bfe_u32 v6, v1, 1, 1
    v_lshl_or_b32 v5, v6, 3, v5
    v_lshrrev_b32 v6, 1, v3
    v_lshl_add_u32 v4, v6, 3, v4
    v_and_b32 v3, 1, v3
    s_and_b32 s60, s30, 1
    s_lshr_b32 s61, s30, 1
    v_and_b32 v6, 31, v1
    v_bfe_u32 v60, v1, 2, 2
    v_lshrrev_b32 v61, 5, v1
    v_xor_b32 v61, v61, v60
    v_xor_b32 v60, 2, v61
    v_lshlrev_b32 v6, 6, v6
    s_lshl_b32 s14, s60, 12
    s_add_u32 s14, s14, 18432
    v_add_u32 v6, s14, v6
    v_lshl_add_u32 v53, v61, 4, v6
    v_lshl_add_u32 v54, v60, 4, v6
    s_lshl_b32 s62, s61, 1
    v_lshlrev_b32 v48, 6, v4
    v_lshl_add_u32 v48, v3, 5, v48
    v_add_u32 v48, v48, v5
    v_add_u32 v48, 16384, v48
    s_cmp_eq_u32 s3, 0
    s_cbranch_scc1 L_c_tB
    v_and_b32 v6, 3, v4
    v_lshl_or_b32 v6, v6, 1, v3
    v_xor_b32 v6, s62, v6
    v_lshlrev_b32 v60, 13, v3
    v_lshl_add_u32 v60, v4, 8, v60
    v_add_u32 v60, v60, v5
    v_lshl_add_u32 v55, v6, 5, v60
    v_xor_b32 v59, 32, v55
    s_mov_b32 s14, 1024
    s_branch L_c_u1done
L_c_tB:
    v_mul_u32_u24 v6, 6176, v3
    v_mul_u32_u24 v60, 192, v4
    v_add3_u32 v6, v6, v60, v5
    s_lshl_b32 s14, s61, 6
    v_add_u32 v55, s14, v6
    v_add_u32 v59, 32, v55
    s_mov_b32 s14, 768
L_c_u1done:
    s_lshl_b32 s15, s14, 2
    v_add_u32 v56, s14, v55
    v_add_u32 v57, s15, v55
    v_add_u32 v58, s14, v57
    v_add_u32 v60, s14, v59
    v_add_u32 v61, s15, v59
    v_add_u32 v62, s14, v61
    s_mov_b32 s99, 0
    s_cmp_eq_u32 s3, 0
    s_cbranch_scc1 L_c_vB
    s_add_u32 s65, s61, 1
    s_cmp_lt_u32 s30, 4
    s_cselect_b32 s99, s65, 0
    s_branch L_c_vdone
L_c_vB:
    s_cmp_eq_u32 s61, 3
    s_cselect_b32 s99, 3, 0
L_c_vdone:
    s_cmp_eq_u32 s30, 0
    s_cselect_b32 s69, 8, 99
    s_cmp_eq_u32 s30, 7
    s_cselect_b32 s69, 99, s69
    s_mov_b32 s68, 0
    s_mov_b32 s63, 26624
    s_mov_b32 s64, 0
    s_cmp_eq_u32 s99, 1
    s_cbranch_scc1 L_c_var1
    s_cmp_eq_u32 s99, 2
    s_cbranch_scc1 L_c_var2
    s_cmp_eq_u32 s99, 3
    s_cbranch_scc1 L_c_var3
L_c_var0:
    s_barrier
    ds_read_b128 v[8:11], v53
    ds_read_b64_tr_b16 v[16:17], v55
    ds_read_b64_tr_b16 v[18:19], v56
    ds_read_b64_tr_b16 v[20:21], v59
    ds_read_b64_tr_b16 v[22:23], v60
    ds_read_b128 v[12:15], v53 offset:2048
    s_waitcnt lgkmcnt(0)
    v_mfma_f32_32x32x16_bf16 v[64:79], v[16:19], v[8:11], 0
    ds_read_b128 v[28:31], v54
    ds_read_b64_tr_b16 v[36:37], v57
    ds_read_b64_tr_b16 v[38:39], v58
    v_mfma_f32_32x32x16_bf16 v[80:95], v[20:23], v[8:11], 0
    ds_read_b64_tr_b16 v[40:41], v61
    ds_read_b64_tr_b16 v[42:43], v62
    ds_read_b128 v[32:35], v54 offset:2048
    v_mfma_f32_32x32x16_bf16 v[96:111], v[16:19], v[12:15], 0
    v_add_u32 v128, s63, v53
    v_add_u32 v129, s63, v54
    v_add_u32 v130, s63, v55
    v_add_u32 v131, s63, v56
    v_add_u32 v132, s63, v57
    v_add_u32 v133, s63, v58
    v_add_u32 v134, s63, v59
    v_add_u32 v135, s63, v60
    v_add_u32 v136, s63, v61
    v_add_u32 v137, s63, v62
    v_mfma_f32_32x32x16_bf16 v[112:127], v[20:23], v[12:15], 0
    s_branch L_c_noside0
L_c_loop0:
    s_waitcnt lgkmcnt(0)
    v_mfma_f32_32x32x16_bf16 v[64:79], v[16:19], v[8:11], v[64:79]
    ds_read_b128 v[28:31], v129
    ds_read_b64_tr_b16 v[36:37], v132
    ds_read_b64_tr_b16 v[38:39], v133
    v_mfma_f32_32x32x16_bf16 v[80:95], v[20:23], v[8:11], v[80:95]
    ds_read_b64_tr_b16 v[40:41], v136
    ds_read_b64_tr_b16 v[42:43], v137
    ds_read_b128 v[32:35], v129 offset:2048
    v_mfma_f32_32x32x16_bf16 v[96:111], v[16:19], v[12:15], v[96:111]
    v_add_u32 v128, s63, v53
    v_add_u32 v129, s63, v54
    v_add_u32 v130, s63, v55
    v_add_u32 v131, s63, v56
    v_add_u32 v132, s63, v57
    v_add_u32 v133, s63, v58
    v_add_u32 v134, s63, v59
    v_add_u32 v135, s63, v60
    v_add_u32 v136, s63, v61
    v_add_u32 v137, s63, v62
    s_cmp_eq_u32 s64, s69
    v_mfma_f32_32x32x16_bf16 v[112:127], v[20:23], v[12:15], v[112:127]
    s_cbranch_scc1 L_c_side
L_c_noside0:
    s_waitcnt lgkmcnt(0)
    s_barrier
    v_mfma_f32_32x32x16_bf16 v[64:79], v[36:39], v[28:31], v[64:79]
    ds_read_b128 v[8:11], v128
    ds_read_b64_tr_b16 v[16:17], v130
    ds_read_b64_tr_b16 v[18:19], v131
    v_mfma_f32_32x32x16_bf16 v[80:95], v[40:43], v[28:31], v[80:95]
    ds_read_b64_tr_b16 v[20:21], v134
    ds_read_b64_tr_b16 v[22:23], v135
    ds_read_b128 v[12:15], v128 offset:2048
    v_mfma_f32_32x32x16_bf16 v[96:111], v[36:39], v[32:35], v[96:111]
    s_add_u32 s63, s63, 26624
    s_cmp_eq_u32 s63, 133120
    s_cselect_b32 s63, 0, s63
    s_add_u32 s64, s64, 1
    s_cmp_lt_u32 s64, 16
    v_mfma_f32_32x32x16_bf16 v[112:127], v[40:43], v[32:35], v[112:127]
    s_cbranch_scc1 L_c_loop0
    s_branch L_c_p1end
L_c_var1:
    s_barrier
    ds_read_b128 v[8:11], v53
    ds_read_b64_tr_b16 v[16:17], v55
    ds_read_b64_tr_b16 v[18:19], v56
    ds_read_b64_tr_b16 v[20:21], v59
    ds_read_b64_tr_b16 v[22:23], v60
    ds_read_b128 v[12:15], v53 offset:2048
    ds_read_b64_tr_b16 v[24:25], v48 offset:0
    ds_read_b64_tr_b16 v[26:27], v48 offset:256
    s_waitcnt lgkmcnt(0)
    v_mfma_f32_32x32x16_bf16 v[64:79], v[16:19], v[8:11], 0
    ds_read_b128 v[28:31], v54
    ds_read_b64_tr_b16 v[36:37], v57
    ds_read_b64_tr_b16 v[38:39], v58
    v_mfma_f32_32x32x16_bf16 v[80:95], v[20:23], v[8:11], 0
    ds_read_b64_tr_b16 v[40:41], v61
    ds_read_b64_tr_b16 v[42:43], v62
    ds_read_b128 v[32:35], v54 offset:2048
    v_mfma_f32_32x32x16_bf16 v[138:153], v[24:27], v[8:11], 0
    ds_read_b64_tr_b16 v[44:45], v48 offset:1024
    ds_read_b64_tr_b16 v[46:47], v48 offset:1280
    v_mfma_f32_32x32x16_bf16 v[96:111], v[16:19], v[12:15], 0
    v_add_u32 v128, s63, v53
    v_add_u32 v129, s63, v54
    v_add_u32 v130, s63, v55
    v_add_u32 v131, s63, v56
    v_add_u32 v132, s63, v57
    v_add_u32 v133, s63, v58
    v_add_u32 v134, s63, v59
    v_add_u32 v135, s63, v60
    v_add_u32 v136, s63, v61
    v_add_u32 v137, s63, v62
    v_add_u32 v154, s63, v48
    v_mfma_f32_32x32x16_bf16 v[112:127], v[20:23], v[12:15], 0
    s_branch L_c_noside1
L_c_loop1:
    s_waitcnt lgkmcnt(0)
    v_mfma_f32_32x32x16_bf16 v[64:79], v[16:19], v[8:11], v[64:79]
    ds_read_b128 v[28:31], v129
    ds_read_b64_tr_b16 v[36:37], v132
    ds_read_b64_tr_b16 v[38:39], v133
    v_mfma_f32_32x32x16_bf16 v[80:95], v[20:23], v[8:11], v[80:95]
    ds_read_b64_tr_b16 v[40:41], v136
    ds_read_b64_tr_b16 v[42:43], v137
    ds_read_b128 v[32:35], v129 offset:2048
    v_mfma_f32_32x32x16_bf16 v[138:153], v[24:27], v[8:11], v[138:153]
    ds_read_b64_tr_b16 v[44:45], v154 offset:1024
    ds_read_b64_tr_b16 v[46:47], v154 offset:1280
    v_mfma_f32_32x32x16_bf16 v[96:111], v[16:19], v[12:15], v[96:111]
    v_add_u32 v128, s63, v53
    v_add_u32 v129, s63, v54
    v_add_u32 v130, s63, v55
    v_add_u32 v131, s63, v56
    v_add_u32 v132, s63, v57
    v_add_u32 v133, s63, v58
    v_add_u32 v134, s63, v59
    v_add_u32 v135, s63, v60
    v_add_u32 v136, s63, v61
    v_add_u32 v137, s63, v62
    v_add_u32 v154, s63, v48
    s_cmp_eq_u32 s64, s69
    v_mfma_f32_32x32x16_bf16 v[112:127], v[20:23], v[12:15], v[112:127]
    s_cbranch_scc1 L_c_side
L_c_noside1:
    s_waitcnt lgkmcnt(0)
    s_barrier
    v_mfma_f32_32x32x16_bf16 v[64:79], v[36:39], v[28:31], v[64:79]
    ds_read_b128 v[8:11], v128
    ds_read_b64_tr_b16 v[16:17], v130
    ds_read_b64_tr_b16 v[18:19], v131
    v_mfma_f32_32x32x16_bf16 v[80:95], v[40:43], v[28:31], v[80:95]
    ds_read_b64_tr_b16 v[20:21], v134
    ds_read_b64_tr_b16 v[22:23], v135
    ds_read_b128 v[12:15], v128 offset:2048
    v_mfma_f32_32x32x16_bf16 v[138:153], v[44:47], v[28:31], v[138:153]
    ds_read_b64_tr_b16 v[24:25], v154 offset:0
    ds_read_b64_tr_b16 v[26:27], v154 offset:256
    v_mfma_f32_32x32x16_bf16 v[96:111], v[36:39], v[32:35], v[96:111]
    s_add_u32 s63, s63, 26624
    s_cmp_eq_u32 s63, 133120
    s_cselect_b32 s63, 0, s63
    s_add_u32 s64, s64, 1
    s_cmp_lt_u32 s64, 16
    v_mfma_f32_32x32x16_bf16 v[112:127], v[40:43], v[32:35], v[112:127]
    s_cbranch_scc1 L_c_loop1
    s_branch L_c_p1end
L_c_var2:
    s_barrier
    ds_read_b128 v[8:11], v53
    ds_read_b64_tr_b16 v[16:17], v55
    ds_read_b64_tr_b16 v[18:19], v56
    ds_read_b64_tr_b16 v[20:21], v59
    ds_read_b64_tr_b16 v[22:23], v60
    ds_read_b128 v[12:15], v53 offset:2048
    ds_read_b64_tr_b16 v[24:25], v48 offset:0
    ds_read_b64_tr_b16 v[26:27], v48 offset:256
    s_waitcnt lgkmcnt(0)
    v_mfma_f32_32x32x16_bf16 v[64:79], v[16:19], v[8:11], 0
    ds_read_b128 v[28:31], v54
    ds_read_b64_tr_b16 v[36:37], v57
    ds_read_b64_tr_b16 v[38:39], v58
    v_mfma_f32_32x32x16_bf16 v[80:95], v[20:23], v[8:11], 0
    ds_read_b64_tr_b16 v[40:41], v61
    ds_read_b64_tr_b16 v[42:43], v62
    ds_read_b128 v[32:35], v54 offset:2048
    v_mfma_f32_32x32x16_bf16 v[138:153], v[24:27], v[12:15], 0
    ds_read_b64_tr_b16 v[44:45], v48 offset:1024
    ds_read_b64_tr_b16 v[46:47], v48 offset:1280
    v_mfma_f32_32x32x16_bf16 v[96:111], v[16:19], v[12:15], 0
    v_add_u32 v128, s63, v53
    v_add_u32 v129, s63, v54
    v_add_u32 v130, s63, v55
    v_add_u32 v131, s63, v56
    v_add_u32 v132, s63, v57
    v_add_u32 v133, s63, v58
    v_add_u32 v134, s63, v59
    v_add_u32 v135, s63, v60
    v_add_u32 v136, s63, v61
    v_add_u32 v137, s63, v62
    v_add_u32 v154, s63, v48
    v_mfma_f32_32x32x16_bf16 v[112:127], v[20:23], v[12:15], 0
    s_branch L_c_noside2
L_c_loop2:
    s_waitcnt lgkmcnt(0)
    v_mfma_f32_32x32x16_bf16 v[64:79], v[16:19], v[8:11], v[64:79]
    ds_read_b128 v[28:31], v129
    ds_read_b64_tr_b16 v[36:37], v132
    ds_read_b64_tr_b16 v[38:39], v133
    v_mfma_f32_32x32x16_bf16 v[80:95], v[20:23], v[8:11], v[80:95]
    ds_read_b64_tr_b16 v[40:41], v136
    ds_read_b64_tr_b16 v[42:43], v137
    ds_read_b128 v[32:35], v129 offset:2048
    v_mfma_f32_32x32x16_bf16 v[138:153], v[24:27], v[12:15], v[138:153]
    ds_read_b64_tr_b16 v[44:45], v154 offset:1024
    ds_read_b64_tr_b16 v[46:47], v154 offset:1280
    v_mfma_f32_32x32x16_bf16 v[96:111], v[16:19], v[12:15], v[96:111]
    v_add_u32 v128, s63, v53
    v_add_u32 v129, s63, v54
    v_add_u32 v130, s63, v55
    v_add_u32 v131, s63, v56
    v_add_u32 v132, s63, v57
    v_add_u32 v133, s63, v58
    v_add_u32 v134, s63, v59
    v_add_u32 v135, s63, v60
    v_add_u32 v136, s63, v61
    v_add_u32 v137, s63, v62
    v_add_u32 v154, s63, v48
    v_mfma_f32_32x32x16_bf16 v[112:127], v[20:23], v[12:15], v[112:127]
L_c_noside2:
    s_waitcnt lgkmcnt(0)
    s_barrier
    v_mfma_f32_32x32x16_bf16 v[64:79], v[36:39], v[28:31], v[64:79]
    ds_read_b128 v[8:11], v128
    ds_read_b64_tr_b16 v[16:17], v130
    ds_read_b64_tr_b16 v[18:19], v131
    v_mfma_f32_32x32x16_bf16 v[80:95], v[40:43], v[28:31], v[80:95]
    ds_read_b64_tr_b16 v[20:21], v134
    ds_read_b64_tr_b16 v[22:23], v135
    ds_read_b128 v[12:15], v128 offset:2048
    v_mfma_f32_32x32x16_bf16 v[138:153], v[44:47], v[32:35], v[138:153]
    ds_read_b64_tr_b16 v[24:25], v154 offset:0
    ds_read_b64_tr_b16 v[26:27], v154 offset:256
    v_mfma_f32_32x32x16_bf16 v[96:111], v[36:39], v[32:35], v[96:111]
    s_add_u32 s63, s63, 26624
    s_cmp_eq_u32 s63, 133120
    s_cselect_b32 s63, 0, s63
    s_add_u32 s64, s64, 1
    s_cmp_lt_u32 s64, 16
    v_mfma_f32_32x32x16_bf16 v[112:127], v[40:43], v[32:35], v[112:127]
    s_cbranch_scc1 L_c_loop2
    s_branch L_c_p1end
L_c_var3:
    s_barrier
    ds_read_b128 v[8:11], v53
    ds_read_b64_tr_b16 v[24:25], v48 offset:0
    ds_read_b64_tr_b16 v[26:27], v48 offset:256
    ds_read_b128 v[12:15], v53 offset:2048
    s_waitcnt lgkmcnt(0)
    v_mfma_f32_32x32x16_bf16 v[64:79], v[24:27], v[8:11], 0
    ds_read_b128 v[28:31], v54
    ds_read_b64_tr_b16 v[44:45], v48 offset:1024
    ds_read_b64_tr_b16 v[46:47], v48 offset:1280
    ds_read_b128 v[32:35], v54 offset:2048
    v_add_u32 v128, s63, v53
    v_add_u32 v129, s63, v54
    v_add_u32 v154, s63, v48
    v_mfma_f32_32x32x16_bf16 v[96:111], v[24:27], v[12:15], 0
    s_branch L_c_noside3
L_c_loop3:
    s_waitcnt lgkmcnt(0)
    v_mfma_f32_32x32x16_bf16 v[64:79], v[24:27], v[8:11], v[64:79]
    ds_read_b128 v[28:31], v129
    ds_read_b64_tr_b16 v[44:45], v154 offset:1024
    ds_read_b64_tr_b16 v[46:47], v154 offset:1280
    ds_read_b128 v[32:35], v129 offset:2048
    v_add_u32 v128, s63, v53
    v_add_u32 v129, s63, v54
    v_add_u32 v154, s63, v48
    s_cmp_eq_u32 s64, s69
    v_mfma_f32_32x32x16_bf16 v[96:111], v[24:27], v[12:15], v[96:111]
    s_cbranch_scc1 L_c_side3
L_c_noside3:
    s_waitcnt lgkmcnt(0)
    s_barrier
    v_mfma_f32_32x32x16_bf16 v[64:79], v[44:47], v[28:31], v[64:79]
    ds_read_b128 v[8:11], v128
    ds_read_b64_tr_b16 v[24:25], v154 offset:0
    ds_read_b64_tr_b16 v[26:27], v154 offset:256
    ds_read_b128 v[12:15], v128 offset:2048
    s_add_u32 s63, s63, 26624
    s_cmp_eq_u32 s63, 133120
    s_cselect_b32 s63, 0, s63
    s_add_u32 s64, s64, 1
    s_cmp_lt_u32 s64, 16
    v_mfma_f32_32x32x16_bf16 v[96:111], v[44:47], v[32:35], v[96:111]
    s_cbranch_scc1 L_c_loop3
    s_branch L_c_p1end
L_c_noside:
    s_cmp_eq_u32 s99, 0
    s_cbranch_scc1 L_c_noside0
    s_branch L_c_noside1
L_c_side3:
    global_load_dword v160, v[158:159], off
    v_add_co_u32 v158, vcc, v158, v157
    s_add_u32 s69, s69, 2
    s_sub_u32 s68, s68, 1
    v_addc_co_u32 v159, vcc, 0, v159, vcc
    s_cmp_eq_u32 s68, 0
    s_cselect_b32 s69, 99, s69
    s_branch L_c_noside3
L_c_side:
    s_cmp_lg_u32 s30, 0
    s_cbranch_scc1 L_c_noside
L_c_side10:
    v_lshlrev_b32 v6, 7, v1
    s_cmp_eq_u32 s64, 11
    s_cbranch_scc1 L_c_side11
    s_mov_b32 s69, 11
    s_mov_b64 exec, 3
    global_load_dword v161, v6, s[26:27] sc1
    s_mov_b64 exec, -1
    s_branch L_c_noside
L_c_side11:
    s_mov_b32 s69, 99
    s_mov_b64 exec, 3
    s_waitcnt vmcnt(0)
    v_cmp_gt_u32 vcc, 64, v161
    s_mov_b64 exec, -1
    s_nop 1
    s_cbranch_vccz L_c_noside
    s_mov_b64 exec, 3
    s_mov_b32 s35, 0
L_kv_poll:
    global_load_dword v7, v6, s[26:27] sc1
    s_add_u32 s35, s35, 1
    s_waitcnt vmcnt(0)
    v_cmp_gt_u32 vcc, 64, v7
    s_cmp_ge_u32 s35, 200000
    s_cbranch_scc1 L_kv_pdone
    s_nop 1
    s_cbranch_vccz L_kv_pdone
    s_sleep 32
    s_branch L_kv_poll
L_kv_pdone:
    s_mov_b64 exec, -1
    s_branch L_c_noside
L_c_p1end:
    s_waitcnt lgkmcnt(0)
    s_nop 7
    s_lshl_b32 s66, s31, 2
    s_lshl_b32 s65, s60, 1
    s_add_u32 s66, s66, s65
    v_mov_b32 v8, 0x3eb8aa3b
    v_mov_b32 v9, 0x3eb8aa3b
    s_lshl_b32 s65, s60, 12
    s_add_u32 s65, s65, 131072
    s_cmp_eq_u32 s99, 3
    s_cbranch_scc1 L_c_qep
    s_cmp_eq_u32 s99, 0
    s_cbranch_scc1 L_c_hep
    s_lshl_b32 s67, s61, 11
    s_add_u32 s65, s65, s67
    v_add_u32 v6, s65, v2
    v_pk_mul_f32 v[138:139], v[138:139], v[8:9]
    v_pk_mul_f32 v[140:141], v[140:141], v[8:9]
    v_pk_mul_f32 v[142:143], v[142:143], v[8:9]
    v_pk_mul_f32 v[144:145], v[144:145], v[8:9]
    v_pk_mul_f32 v[146:147], v[146:147], v[8:9]
    v_pk_mul_f32 v[148:149], v[148:149], v[8:9]
    v_pk_mul_f32 v[150:151], v[150:151], v[8:9]
    v_pk_mul_f32 v[152:153], v[152:153], v[8:9]
    v_cvt_pk_bf16_f32 v16, v138, v139
    v_cvt_pk_bf16_f32 v17, v140, v141
    v_cvt_pk_bf16_f32 v18, v142, v143
    v_cvt_pk_bf16_f32 v19, v144, v145
    v_cvt_pk_bf16_f32 v20, v146, v147
    v_cvt_pk_bf16_f32 v21, v148, v149
    v_cvt_pk_bf16_f32 v22, v150, v151
    v_cvt_pk_bf16_f32 v23, v152, v153
    ds_write_b128 v6, v[16:19]
    ds_write_b128 v6, v[20:23] offset:1024
L_c_hep:
    s_mul_i32 s67, s66, 144
    s_add_u32 s67, s67, s98
    s_add_u32 s67, s67, s62
    s_lshl_b32 s67, s67, 10
    s_add_u32 s67, s67, 4194304
    s_add_u32 s68, s67, 147456
    v_pk_mul_f32 v[64:65], v[64:65], v[72:73]
    v_pk_mul_f32 v[66:67], v[66:67], v[74:75]
    v_pk_mul_f32 v[68:69], v[68:69], v[76:77]
    v_pk_mul_f32 v[70:71], v[70:71], v[78:79]
    v_cvt_pk_bf16_f32 v144, v64, v65
    v_cvt_pk_bf16_f32 v145, v66, v67
    v_cvt_pk_bf16_f32 v146, v68, v69
    v_cvt_pk_bf16_f32 v147, v70, v71
    v_pk_mul_f32 v[96:97], v[96:97], v[104:105]
    v_pk_mul_f32 v[98:99], v[98:99], v[106:107]
    v_pk_mul_f32 v[100:101], v[100:101], v[108:109]
    v_pk_mul_f32 v[102:103], v[102:103], v[110:111]
    v_cvt_pk_bf16_f32 v152, v96, v97
    v_cvt_pk_bf16_f32 v153, v98, v99
    v_cvt_pk_bf16_f32 v154, v100, v101
    v_cvt_pk_bf16_f32 v155, v102, v103
    v_pk_mul_f32 v[80:81], v[80:81], v[88:89]
    v_pk_mul_f32 v[82:83], v[82:83], v[90:91]
    v_pk_mul_f32 v[84:85], v[84:85], v[92:93]
    v_pk_mul_f32 v[86:87], v[86:87], v[94:95]
    v_cvt_pk_bf16_f32 v148, v80, v81
    v_cvt_pk_bf16_f32 v149, v82, v83
    v_cvt_pk_bf16_f32 v150, v84, v85
    v_cvt_pk_bf16_f32 v151, v86, v87
    v_pk_mul_f32 v[112:113], v[112:113], v[120:121]
    v_pk_mul_f32 v[114:115], v[114:115], v[122:123]
    v_pk_mul_f32 v[116:117], v[116:117], v[124:125]
    v_pk_mul_f32 v[118:119], v[118:119], v[126:127]
    v_cvt_pk_bf16_f32 v156, v112, v113
    v_cvt_pk_bf16_f32 v157, v114, v115
    v_cvt_pk_bf16_f32 v158, v116, v117
    v_cvt_pk_bf16_f32 v159, v118, v119
    s_waitcnt lgkmcnt(0)
    s_branch L_c_epdone
L_c_qep:
    v_add_u32 v6, s65, v2
    v_pk_mul_f32 v[64:65], v[64:65], v[8:9]
    v_pk_mul_f32 v[66:67], v[66:67], v[8:9]
    v_pk_mul_f32 v[68:69], v[68:69], v[8:9]
    v_pk_mul_f32 v[70:71], v[70:71], v[8:9]
    v_pk_mul_f32 v[72:73], v[72:73], v[8:9]
    v_pk_mul_f32 v[74:75], v[74:75], v[8:9]
    v_pk_mul_f32 v[76:77], v[76:77], v[8:9]
    v_pk_mul_f32 v[78:79], v[78:79], v[8:9]
    v_cvt_pk_bf16_f32 v64, v64, v65
    v_cvt_pk_bf16_f32 v65, v66, v67
    v_cvt_pk_bf16_f32 v66, v68, v69
    v_cvt_pk_bf16_f32 v67, v70, v71
    v_cvt_pk_bf16_f32 v68, v72, v73
    v_cvt_pk_bf16_f32 v69, v74, v75
    v_cvt_pk_bf16_f32 v70, v76, v77
    v_cvt_pk_bf16_f32 v71, v78, v79
    ds_write_b128 v6, v[64:67] offset:0
    ds_write_b128 v6, v[68:71] offset:1024
    v_pk_mul_f32 v[96:97], v[96:97], v[8:9]
    v_pk_mul_f32 v[98:99], v[98:99], v[8:9]
    v_pk_mul_f32 v[100:101], v[100:101], v[8:9]
    v_pk_mul_f32 v[102:103], v[102:103], v[8:9]
    v_pk_mul_f32 v[104:105], v[104:105], v[8:9]
    v_pk_mul_f32 v[106:107], v[106:107], v[8:9]
    v_pk_mul_f32 v[108:109], v[108:109], v[8:9]
    v_pk_mul_f32 v[110:111], v[110:111], v[8:9]
    v_cvt_pk_bf16_f32 v96, v96, v97
    v_cvt_pk_bf16_f32 v97, v98, v99
    v_cvt_pk_bf16_f32 v98, v100, v101
    v_cvt_pk_bf16_f32 v99, v102, v103
    v_cvt_pk_bf16_f32 v100, v104, v105
    v_cvt_pk_bf16_f32 v101, v106, v107
    v_cvt_pk_bf16_f32 v102, v108, v109
    v_cvt_pk_bf16_f32 v103, v110, v111
    ds_write_b128 v6, v[96:99] offset:2048
    ds_write_b128 v6, v[100:103] offset:3072
L_c_epdone:
    s_lshl_b32 s65, s72, 7
    s_add_u32 s65, s65, 131072
    v_and_b32 v3, 31, v1
    v_lshlrev_b32 v3, 2, v3
    buffer_load_dword v31, v3, s[40:43], s65 offen sc1
    s_add_u32 s65, s71, 7
    s_lshl_b32 s65, s65, 12
    v_add_u32 v29, s65, v2
    v_lshrrev_b32 v3, 5, v1
    v_and_b32 v32, 15, v1
    v_lshl_add_u32 v3, v3, 4, v32
    v_lshlrev_b32 v3, 4, v3
    v_add_u32 v138, 65536, v3
    v_add_u32 v30, s65, v138
    v_mov_b32 v28, 0xdddddddd
    v_and_b32 v3, 27, v1
    v_cmp_eq_u32 vcc, 16, v3
    v_mov_b32 v3, 0x3f803f80
    s_lshl_b32 s65, s70, 2
    v_cndmask_b32 v3, 0, v3, vcc
    v_mov_b32 v20, v3
    v_mov_b32 v21, v3
    v_pk_mov_b32 v[22:23], v[20:21], v[20:21] op_sel:[0,1]
    v_pk_mov_b32 v[24:25], v[20:21], v[20:21] op_sel:[0,1]
    v_pk_mov_b32 v[26:27], v[20:21], v[20:21] op_sel:[0,1]
    v_pk_mov_b32 v[128:129], v[20:21], v[20:21] op_sel:[0,1]
    v_pk_mov_b32 v[130:131], v[20:21], v[20:21] op_sel:[0,1]
    v_pk_mov_b32 v[132:133], v[20:21], v[20:21] op_sel:[0,1]
    v_pk_mov_b32 v[134:135], v[20:21], v[20:21] op_sel:[0,1]
    s_mov_b32 s74, 0x0000ffff
    s_mov_b32 s75, 0x0000ffff
    s_add_u32 s65, s65, 162304
    v_mov_b32 v139, s65
    v_mov_b32 v140, 1
    s_lshl_b32 s65, s70, 11
    s_add_u32 s65, s65, 131072
    v_add_u32 v3, s65, v2
    v_mov_b32 v33, 162356
    s_waitcnt lgkmcnt(0)
    v_mov_b32 v96, 0
    v_mov_b32 v97, 0
    v_pk_mov_b32 v[98:99], v[96:97], v[96:97] op_sel:[0,1]
    v_pk_mov_b32 v[100:101], v[96:97], v[96:97] op_sel:[0,1]
    v_pk_mov_b32 v[102:103], v[96:97], v[96:97] op_sel:[0,1]
    v_pk_mov_b32 v[104:105], v[96:97], v[96:97] op_sel:[0,1]
    v_pk_mov_b32 v[112:113], v[96:97], v[96:97] op_sel:[0,1]
    v_pk_mov_b32 v[114:115], v[96:97], v[96:97] op_sel:[0,1]
    v_pk_mov_b32 v[116:117], v[96:97], v[96:97] op_sel:[0,1]
    v_pk_mov_b32 v[118:119], v[96:97], v[96:97] op_sel:[0,1]
    v_pk_mov_b32 v[120:121], v[96:97], v[96:97] op_sel:[0,1]
    v_pk_mov_b32 v[88:89], v[96:97], v[96:97] op_sel:[0,1]
    v_pk_mov_b32 v[90:91], v[96:97], v[96:97] op_sel:[0,1]
    v_pk_mov_b32 v[92:93], v[96:97], v[96:97] op_sel:[0,1]
    v_pk_mov_b32 v[94:95], v[96:97], v[96:97] op_sel:[0,1]
    s_barrier
    ds_read_b128 v[4:7], v3
    ds_read_b128 v[12:15], v29
    ds_read_b128 v[8:11], v3 offset:1024
    ds_read_b128 v[16:19], v29 offset:1024
    s_mov_b64 exec, s[74:75]
    ds_read_b128 v[20:23], v30
    ds_read_b128 v[24:27], v30 offset:512
    s_mov_b64 exec, 1
    ds_add_u32 v33, v140
    s_mov_b64 exec, -1
    s_waitcnt lgkmcnt(0)
    v_mfma_f32_32x32x16_bf16 v[32:47], v[12:15], v[4:7], 0
    v_mfma_f32_32x32x16_bf16 v[64:79], v[12:15], v[8:11], 0
    s_nop 15
    s_cmp_lg_u32 s99, 3
    s_cselect_b64 vcc, -1, 0
    s_mov_b32 s79, 0
    s_mov_b32 s73, 0
    s_cmp_lg_u32 s71, 0
    s_cbranch_scc1 L_a_job
    s_setprio 2
L_a_loop:
    s_waitcnt lgkmcnt(0)
    ds_read_b128 v[12:15], v29 offset:2048
    v_exp_f32 v32, v32
    v_exp_f32 v33, v33
    v_smfmac_f32_32x32x32_bf16 v[112:127], v[132:135], v[88:95], v28
    s_mov_b64 exec, s[74:75]
    ds_read_b128 v[128:131], v30 offset:1024
    ds_read_b128 v[132:135], v30 offset:1536
    s_mov_b64 exec, 1
    ds_add_rtn_u32 v141, v139, v140
    s_mov_b64 exec, -1
    v_exp_f32 v34, v34
    v_exp_f32 v35, v35
    v_exp_f32 v36, v36
    v_exp_f32 v37, v37
    v_mfma_f32_32x32x16_bf16 v[48:63], v[16:19], v[4:7], 0
    v_exp_f32 v38, v38
    v_exp_f32 v39, v39
    v_exp_f32 v40, v40
    v_exp_f32 v41, v41
    v_exp_f32 v42, v42
    v_smfmac_f32_32x32x32_bf16 v[96:111], v[20:23], v[32:39], v28
    v_exp_f32 v43, v43
    v_exp_f32 v44, v44
    v_exp_f32 v45, v45
    v_exp_f32 v46, v46
    v_exp_f32 v47, v47
    v_exp_f32 v64, v64
    v_exp_f32 v65, v65
    v_smfmac_f32_32x32x32_bf16 v[96:111], v[24:27], v[40:47], v28
    v_exp_f32 v66, v66
    v_exp_f32 v67, v67
    v_exp_f32 v68, v68
    v_exp_f32 v69, v69
    v_mfma_f32_32x32x16_bf16 v[80:95], v[16:19], v[8:11], 0
    v_exp_f32 v70, v70
    v_exp_f32 v71, v71
    v_exp_f32 v72, v72
    v_exp_f32 v73, v73
    v_exp_f32 v74, v74
    v_smfmac_f32_32x32x32_bf16 v[112:127], v[20:23], v[64:71], v28
    v_exp_f32 v75, v75
    v_exp_f32 v76, v76
    v_exp_f32 v77, v77
    v_exp_f32 v78, v78
    v_exp_f32 v79, v79
    s_cbranch_vccnz L_a_hs0
L_a_hsr0:
    s_waitcnt lgkmcnt(0)
    v_readfirstlane_b32 s73, v141
    ds_read_b128 v[16:19], v29 offset:3072
    v_exp_f32 v48, v48
    v_exp_f32 v49, v49
    v_smfmac_f32_32x32x32_bf16 v[112:127], v[24:27], v[72:79], v28
    s_mov_b64 exec, s[74:75]
    ds_read_b128 v[20:23], v30 offset:2048
    ds_read_b128 v[24:27], v30 offset:2560
    s_mov_b64 exec, -1
    s_add_u32 s65, s73, 7
    s_and_b32 s65, s65, 15
    s_lshl_b32 s65, s65, 12
    v_exp_f32 v50, v50
    v_exp_f32 v51, v51
    v_exp_f32 v52, v52
    v_exp_f32 v53, v53
    v_mfma_f32_32x32x16_bf16 v[32:47], v[12:15], v[4:7], 0
    v_add_u32 v136, s65, v2
    v_add_u32 v137, s65, v138
    v_exp_f32 v54, v54
    v_exp_f32 v55, v55
    v_exp_f32 v56, v56
    v_exp_f32 v57, v57
    v_exp_f32 v58, v58
    v_smfmac_f32_32x32x32_bf16 v[96:111], v[128:131], v[48:55], v28
    v_exp_f32 v59, v59
    v_exp_f32 v60, v60
    v_exp_f32 v61, v61
    v_exp_f32 v62, v62
    v_exp_f32 v63, v63
    v_exp_f32 v80, v80
    v_exp_f32 v81, v81
    v_smfmac_f32_32x32x32_bf16 v[96:111], v[132:135], v[56:63], v28
    v_exp_f32 v82, v82
    v_exp_f32 v83, v83
    v_exp_f32 v84, v84
    v_exp_f32 v85, v85
    v_mfma_f32_32x32x16_bf16 v[64:79], v[12:15], v[8:11], 0
    v_exp_f32 v86, v86
    v_exp_f32 v87, v87
    v_exp_f32 v88, v88
    v_exp_f32 v89, v89
    v_exp_f32 v90, v90
    v_smfmac_f32_32x32x32_bf16 v[112:127], v[128:131], v[80:87], v28
    v_exp_f32 v91, v91
    v_exp_f32 v92, v92
    v_exp_f32 v93, v93
    v_exp_f32 v94, v94
    v_exp_f32 v95, v95
    s_cbranch_vccnz L_a_hs1
L_a_hsr1:
    s_waitcnt lgkmcnt(0)
    ds_read_b128 v[12:15], v136 offset:0
    v_exp_f32 v32, v32
    v_exp_f32 v33, v33
    v_smfmac_f32_32x32x32_bf16 v[112:127], v[132:135], v[88:95], v28
    s_mov_b64 exec, s[74:75]
    ds_read_b128 v[128:131], v30 offset:3072
    ds_read_b128 v[132:135], v30 offset:3584
    s_mov_b64 exec, -1
    v_exp_f32 v34, v34
    v_exp_f32 v35, v35
    v_exp_f32 v36, v36
    v_exp_f32 v37, v37
    v_mfma_f32_32x32x16_bf16 v[48:63], v[16:19], v[4:7], 0
    v_exp_f32 v38, v38
    v_exp_f32 v39, v39
    v_exp_f32 v40, v40
    v_exp_f32 v41, v41
    v_exp_f32 v42, v42
    v_smfmac_f32_32x32x32_bf16 v[96:111], v[20:23], v[32:39], v28
    v_exp_f32 v43, v43
    v_exp_f32 v44, v44
    v_exp_f32 v45, v45
    v_exp_f32 v46, v46
    v_exp_f32 v47, v47
    v_exp_f32 v64, v64
    v_exp_f32 v65, v65
    v_smfmac_f32_32x32x32_bf16 v[96:111], v[24:27], v[40:47], v28
    v_exp_f32 v66, v66
    v_exp_f32 v67, v67
    v_exp_f32 v68, v68
    v_exp_f32 v69, v69
    v_mfma_f32_32x32x16_bf16 v[80:95], v[16:19], v[8:11], 0
    v_exp_f32 v70, v70
    v_exp_f32 v71, v71
    v_exp_f32 v72, v72
    v_exp_f32 v73, v73
    v_exp_f32 v74, v74
    v_smfmac_f32_32x32x32_bf16 v[112:127], v[20:23], v[64:71], v28
    v_exp_f32 v75, v75
    v_exp_f32 v76, v76
    v_exp_f32 v77, v77
    v_exp_f32 v78, v78
    v_exp_f32 v79, v79
    s_waitcnt lgkmcnt(0)
    ds_read_b128 v[16:19], v136 offset:1024
    v_exp_f32 v48, v48
    v_exp_f32 v49, v49
    v_smfmac_f32_32x32x32_bf16 v[112:127], v[24:27], v[72:79], v28
    s_mov_b64 exec, s[74:75]
    ds_read_b128 v[20:23], v137 offset:0
    ds_read_b128 v[24:27], v137 offset:512
    s_mov_b64 exec, -1
    v_exp_f32 v50, v50
    v_exp_f32 v51, v51
    v_exp_f32 v52, v52
    v_exp_f32 v53, v53
    v_mfma_f32_32x32x16_bf16 v[32:47], v[12:15], v[4:7], 0
    v_exp_f32 v54, v54
    v_exp_f32 v55, v55
    v_exp_f32 v56, v56
    v_exp_f32 v57, v57
    v_exp_f32 v58, v58
    v_smfmac_f32_32x32x32_bf16 v[96:111], v[128:131], v[48:55], v28
    v_exp_f32 v59, v59
    v_exp_f32 v60, v60
    v_exp_f32 v61, v61
    v_exp_f32 v62, v62
    v_exp_f32 v63, v63
    v_exp_f32 v80, v80
    v_exp_f32 v81, v81
    v_smfmac_f32_32x32x32_bf16 v[96:111], v[132:135], v[56:63], v28
    v_exp_f32 v82, v82
    v_exp_f32 v83, v83
    v_exp_f32 v84, v84
    v_exp_f32 v85, v85
    v_mfma_f32_32x32x16_bf16 v[64:79], v[12:15], v[8:11], 0
    v_exp_f32 v86, v86
    v_exp_f32 v87, v87
    v_exp_f32 v88, v88
    v_exp_f32 v89, v89
    v_exp_f32 v90, v90
    v_smfmac_f32_32x32x32_bf16 v[112:127], v[128:131], v[80:87], v28
    v_mov_b32 v29, v136
    v_mov_b32 v30, v137
    v_exp_f32 v91, v91
    v_exp_f32 v92, v92
    v_exp_f32 v93, v93
    v_exp_f32 v94, v94
    v_exp_f32 v95, v95
    s_cmp_eq_u32 s79, 0
    s_cbranch_scc1 L_a_job
L_a_next:
    s_cmp_lt_u32 s73, 16
    s_cbranch_scc1 L_a_loop
    s_mul_i32 s65, s70, 4608
    s_add_u32 s65, s65, 131072
    v_add_u32 v32, s65, v2
    v_lshrrev_b32 v33, 1, v2
    v_add_u32 v33, s65, v33
    s_mov_b64 exec, 1
    ds_add_rtn_u32 v141, v139, v140 offset:16
    v_mov_b32 v3, 162352
    s_mov_b64 exec, -1
    v_smfmac_f32_32x32x32_bf16 v[112:127], v[132:135], v[88:95], v28
    ds_read_b32 v34, v139 offset:32
    ds_read_b128 v[64:67], v32
    ds_read_b128 v[68:71], v32 offset:1024
    ds_read_b128 v[72:75], v32 offset:2048
    ds_read_b128 v[76:79], v32 offset:3072
    ds_read_b64 v[80:81], v33 offset:4096
    s_waitcnt lgkmcnt(0)
    v_readfirstlane_b32 s73, v141
    v_readfirstlane_b32 s65, v34
    s_mov_b32 s79, 0
    s_nop 2
    s_cmp_lg_u32 s65, 0
    s_cbranch_scc1 L_a_comb
    s_cmp_lg_u32 s73, 0
    s_cbranch_scc1 L_a_second
    s_mov_b64 exec, 1
    s_mov_b32 s65, 0
L_a_gd:
    ds_read_b32 v34, v3
    s_add_u32 s65, s65, 1
    s_waitcnt lgkmcnt(0)
    v_cmp_gt_u32 vcc, 4, v34
    s_cmp_ge_u32 s65, 800000
    s_cbranch_scc1 L_a_gd2
    s_nop 1
    s_cbranch_vccnz L_a_gd
L_a_gd2:
    s_mov_b64 exec, -1
    v_mov_b32 v105, v120
    ds_write_b128 v32, v[96:99]
    ds_write_b128 v32, v[100:103] offset:1024
    ds_write_b128 v32, v[112:115] offset:2048
    ds_write_b128 v32, v[116:119] offset:3072
    ds_write_b64 v33, v[104:105] offset:4096
    s_waitcnt lgkmcnt(0)
    s_mov_b64 exec, 1
    ds_write_b32 v139, v140 offset:32
    ds_add_u32 v3, v140 offset:24
    s_endpgm
L_a_second:
    s_mov_b64 exec, 1
    s_mov_b32 s65, 0
L_a_rdy:
    ds_read_b32 v34, v139 offset:32
    s_add_u32 s65, s65, 1
    s_waitcnt lgkmcnt(0)
    v_cmp_eq_u32 vcc, 0, v34
    s_cmp_ge_u32 s65, 800000
    s_cbranch_scc1 L_a_rdy2
    s_nop 1
    s_cbranch_vccnz L_a_rdy
L_a_rdy2:
    s_mov_b64 exec, -1
    ds_read_b128 v[64:67], v32
    ds_read_b128 v[68:71], v32 offset:1024
    ds_read_b128 v[72:75], v32 offset:2048
    ds_read_b128 v[76:79], v32 offset:3072
    ds_read_b64 v[80:81], v33 offset:4096
    s_waitcnt lgkmcnt(0)
L_a_comb:
    v_pk_add_f32 v[96:97], v[96:97], v[64:65]
    v_pk_add_f32 v[112:113], v[112:113], v[72:73]
    v_pk_add_f32 v[98:99], v[98:99], v[66:67]
    v_pk_add_f32 v[114:115], v[114:115], v[74:75]
    v_pk_add_f32 v[100:101], v[100:101], v[68:69]
    v_pk_add_f32 v[116:117], v[116:117], v[76:77]
    v_pk_add_f32 v[102:103], v[102:103], v[70:71]
    v_pk_add_f32 v[118:119], v[118:119], v[78:79]
    v_add_f32 v104, v104, v80
    v_add_f32 v120, v120, v81
L_a_finloop:
    v_add_f32 v35, v96, v97
    v_add_f32 v36, v98, v99
    v_add_f32 v37, v100, v101
    v_add_f32 v34, v102, v103
    v_add_f32 v35, v35, v36
    v_add_f32 v34, v34, v37
    v_add_f32 v35, v35, v34
    v_fma_f32 v35, v35, 0, v104
    v_cmp_nle_f32 vcc, 0x30800000, v35
    s_mov_b64 s[76:77], vcc
    v_cmp_nge_f32 vcc, 0x4e800000, v35
    s_or_b64 s[76:77], s[76:77], vcc
    s_cmp_lg_u64 s[76:77], 0
    s_cbranch_scc1 L_a_fallback
L_a_fin:
    v_rcp_f32 v32, v104
    s_nop 0
    v_mul_f32 v32, v32, v31
    v_mul_f32 v96, v96, v32
    v_mul_f32 v97, v97, v32
    v_mul_f32 v98, v98, v32
    v_mul_f32 v99, v99, v32
    v_mul_f32 v100, v100, v32
    v_mul_f32 v101, v101, v32
    v_mul_f32 v102, v102, v32
    v_mul_f32 v103, v103, v32
    v_cvt_pk_bf16_f32 v36, v96, v97
    v_cvt_pk_bf16_f32 v37, v98, v99
    v_cvt_pk_bf16_f32 v38, v100, v101
    v_cvt_pk_bf16_f32 v39, v102, v103
    v_min_u32 v36, -2, v36
    v_min_u32 v37, -2, v37
    v_min_u32 v38, -2, v38
    v_min_u32 v39, -2, v39
    buffer_store_dwordx4 v[36:39], v2, s[40:43], s78 offen sc1
    s_cmp_lg_u32 s79, 0
    s_cbranch_scc1 L_a_done
    s_mov_b32 s79, 1
    s_add_u32 s78, s78, 1024
    v_mov_b32 v96, v112
    v_mov_b32 v97, v113
    v_mov_b32 v98, v114
    v_mov_b32 v99, v115
    v_mov_b32 v100, v116
    v_mov_b32 v101, v117
    v_mov_b32 v102, v118
    v_mov_b32 v103, v119
    v_mov_b32 v104, v120
    v_mov_b32 v4, v8
    v_mov_b32 v5, v9
    v_mov_b32 v6, v10
    v_mov_b32 v7, v11
    s_branch L_a_finloop
L_a_done:
    v_mov_b32 v3, 162376
    s_mov_b64 exec, 1
    ds_add_u32 v3, v140
    s_mov_b64 exec, -1
    s_endpgm
L_a_hs0:
    buffer_store_dwordx4 v[144:147], v2, s[40:43], s67 offen offset:0 sc1
    buffer_store_dwordx4 v[148:151], v2, s[40:43], s67 offen offset:1024 sc1
    s_branch L_a_hsr0
L_a_hs1:
    buffer_store_dwordx4 v[152:155], v2, s[40:43], s68 offen offset:0 sc1
    buffer_store_dwordx4 v[156:159], v2, s[40:43], s68 offen offset:1024 sc1
    s_branch L_a_hsr1
L_a_job:
    s_mov_b32 s79, 1
    s_cmp_eq_u32 s71, 0
    s_cbranch_scc1 L_a_job1
    s_cbranch_vccz L_a_job1
    buffer_store_dwordx4 v[144:147], v2, s[40:43], s67 offen offset:0 sc1
    buffer_store_dwordx4 v[148:151], v2, s[40:43], s67 offen offset:1024 sc1
    buffer_store_dwordx4 v[152:155], v2, s[40:43], s68 offen offset:0 sc1
    buffer_store_dwordx4 v[156:159], v2, s[40:43], s68 offen offset:1024 sc1
L_a_job1:
    s_waitcnt vmcnt(0)
    s_mov_b64 exec, 1
    v_mov_b32 v3, 162360
    ds_add_u32 v3, v140
    s_mov_b32 s65, 0
L_a_kvw:
    ds_read_b32 v142, v3 offset:4
    s_add_u32 s65, s65, 1
    s_waitcnt lgkmcnt(0)
    v_cmp_gt_u32 vcc, 4, v142
    s_cmp_ge_u32 s65, 800000
    s_cbranch_scc1 L_a_kvw2
    s_nop 1
    s_cbranch_vccnz L_a_kvw
L_a_kvw2:
    s_mov_b64 exec, -1
    s_mov_b64 vcc, 0
    s_branch L_a_next
L_a_fallback:
    v_mov_b32 v3, 0xff800000
    v_mov_b32 v29, v2
    s_mov_b32 s73, 0
L_fb1:
    ds_read_b128 v[12:15], v29
    s_waitcnt lgkmcnt(0)
    v_mfma_f32_32x32x16_bf16 v[48:63], v[12:15], v[4:7], 0
    v_add_u32 v29, 1024, v29
    s_nop 15
    v_max3_f32 v3, v3, v48, v49
    v_max3_f32 v3, v3, v50, v51
    v_max3_f32 v3, v3, v52, v53
    v_max3_f32 v3, v3, v54, v55
    v_max3_f32 v3, v3, v56, v57
    v_max3_f32 v3, v3, v58, v59
    v_max3_f32 v3, v3, v60, v61
    v_max3_f32 v3, v3, v62, v63
    s_add_u32 s73, s73, 1
    s_cmp_lt_u32 s73, 64
    s_cbranch_scc1 L_fb1
    v_mov_b32 v32, v3
    s_nop 1
    v_permlane32_swap_b32 v3, v32
    s_nop 1
    v_max_f32 v3, v3, v32
    v_mov_b32 v96, 0
    v_mov_b32 v97, 0
    v_mov_b32 v98, 0
    v_mov_b32 v99, 0
    v_mov_b32 v100, 0
    v_mov_b32 v101, 0
    v_mov_b32 v102, 0
    v_mov_b32 v103, 0
    v_mov_b32 v104, 0
    v_mov_b32 v105, 0
    v_mov_b32 v106, 0
    v_mov_b32 v107, 0
    v_mov_b32 v108, 0
    v_mov_b32 v109, 0
    v_mov_b32 v110, 0
    v_mov_b32 v111, 0
    v_mov_b32 v29, v2
    v_mov_b32 v30, v138
    s_mov_b32 s73, 0
L_fb2:
    ds_read_b128 v[12:15], v29
    s_mov_b64 exec, s[74:75]
    ds_read_b128 v[20:23], v30
    ds_read_b128 v[24:27], v30 offset:512
    s_mov_b64 exec, -1
    s_waitcnt lgkmcnt(0)
    v_mfma_f32_32x32x16_bf16 v[48:63], v[12:15], v[4:7], 0
    v_add_u32 v29, 1024, v29
    v_add_u32 v30, 1024, v30
    s_nop 15
    v_sub_f32 v48, v48, v3
    v_sub_f32 v49, v49, v3
    v_sub_f32 v50, v50, v3
    v_sub_f32 v51, v51, v3
    v_sub_f32 v52, v52, v3
    v_sub_f32 v53, v53, v3
    v_sub_f32 v54, v54, v3
    v_sub_f32 v55, v55, v3
    v_sub_f32 v56, v56, v3
    v_sub_f32 v57, v57, v3
    v_sub_f32 v58, v58, v3
    v_sub_f32 v59, v59, v3
    v_sub_f32 v60, v60, v3
    v_sub_f32 v61, v61, v3
    v_sub_f32 v62, v62, v3
    v_sub_f32 v63, v63, v3
    v_exp_f32 v48, v48
    v_exp_f32 v49, v49
    v_exp_f32 v50, v50
    v_exp_f32 v51, v51
    v_exp_f32 v52, v52
    v_exp_f32 v53, v53
    v_exp_f32 v54, v54
    v_exp_f32 v55, v55
    v_exp_f32 v56, v56
    v_exp_f32 v57, v57
    v_exp_f32 v58, v58
    v_exp_f32 v59, v59
    v_exp_f32 v60, v60
    v_exp_f32 v61, v61
    v_exp_f32 v62, v62
    v_exp_f32 v63, v63
    s_nop 1
    v_smfmac_f32_32x32x32_bf16 v[96:111], v[20:23], v[48:55], v28
    v_smfmac_f32_32x32x32_bf16 v[96:111], v[24:27], v[56:63], v28
    s_nop 7
    s_add_u32 s73, s73, 1
    s_cmp_lt_u32 s73, 64
    s_cbranch_scc1 L_fb2
    s_nop 15
    s_branch L_a_fin
L_g2:
    s_setprio 1
    s_mov_b32 s48, s20
    s_mov_b32 s49, s21
    s_mov_b32 s50, 1835008
    s_mov_b32 s51, 0x00020000
    s_mov_b32 s52, s12
    s_mov_b32 s53, s13
    s_mov_b32 s54, 524288
    s_mov_b32 s55, 0x00020000
    s_mov_b32 s56, s24
    s_mov_b32 s57, s25
    s_mov_b32 s58, 2097152
    s_mov_b32 s59, 0x00020000
    v_lshrrev_b32 v3, 3, v1
    v_bfe_u32 v4, v1, 4, 1
    v_lshlrev_b32 v4, 2, v4
    v_and_b32 v5, 7, v1
    v_xor_b32 v5, v5, v4
    v_lshlrev_b32 v5, 4, v5
    v_lshl_add_u32 v5, v3, 10, v5
    s_lshl_b32 s14, s34, 7
    v_add_u32 v5, s14, v5
    v_add_u32 v8, 0x2000, v5
    v_lshrrev_b32 v3, 4, v1
    v_bfe_u32 v4, v1, 2, 2
    v_lshrrev_b32 v6, 1, v3
    v_lshl_add_u32 v6, v6, 3, v4
    v_lshlrev_b32 v6, 7, v6
    v_lshrrev_b32 v4, 1, v4
    v_lshl_add_u32 v6, v4, 6, v6
    v_and_b32 v3, 1, v3
    v_lshl_add_u32 v6, v3, 5, v6
    v_and_b32 v3, 1, v1
    v_lshl_add_u32 v6, v3, 4, v6
    v_bfe_u32 v3, v1, 1, 1
    v_lshl_add_u32 v6, v3, 3, v6
    s_mul_i32 s46, s44, 6144
    s_add_u32 s46, s46, 131072
    v_add_u32 v6, s46, v6
    s_and_b32 s14, s44, 1
    s_lshl_b32 s14, s14, 6
    v_xor_b32 v6, s14, v6
    v_xor_b32 v7, 64, v6
    s_lshr_b32 s14, s44, 1
    s_mul_i32 s15, s14, 147456
    v_add_u32 v10, s15, v2
    s_sub_u32 s15, 147456, s15
    v_add_u32 v9, s15, v2
    s_lshl_b32 s14, s33, 8
    s_add_u32 s14, s14, 131072
    v_and_b32 v3, 31, v1
    v_lshlrev_b32 v3, 2, v3
    s_lshr_b32 s15, s44, 1
    s_lshl_b32 s15, s15, 7
    v_xor_b32 v3, s15, v3
    v_xor_b32 v4, 0x80, v3
    buffer_load_dword v12, v3, s[40:43], s14 offen sc1
    buffer_load_dword v13, v4, s[40:43], s14 offen sc1
    s_mul_i32 s64, s44, 458752
    s_lshl_b32 s14, s33, 1
    s_mul_i32 s65, s14, 144
    s_mov_b32 s72, s65
    s_mul_i32 s15, s44, 28
    s_add_u32 s65, s65, s15
    s_lshl_b32 s65, s65, 10
    s_add_u32 s65, s65, 4194304
    v_mov_b32 v3, 162360
    s_mov_b64 exec, 1
    s_mov_b32 s71, 0
L_g_hd:
    ds_read_b32 v4, v3
    s_add_u32 s71, s71, 1
    s_waitcnt lgkmcnt(0)
    v_cmp_gt_u32 vcc, 8, v4
    s_cmp_ge_u32 s71, 800000
    s_cbranch_scc1 L_g_hd2
    s_sleep 2
    s_cbranch_vccnz L_g_hd
L_g_hd2:
    s_cmp_lg_u32 s44, 0
    s_cbranch_scc1 L_g_nosig
    s_lshl_b32 s14, s31, 7
    s_add_u32 s14, s14, 196608
    v_mov_b32 v3, s14
    v_mov_b32 v4, 1
    global_atomic_add v3, v4, s[28:29] sc1
L_g_nosig:
    s_mov_b64 exec, -1
    v_lshlrev_b32 v3, 7, v1
    s_lshr_b32 s74, s2, 3
    s_mul_i32 s75, s74, 57344
    s_lshl_b32 s14, s44, 14
    s_add_u32 s75, s75, s14
    buffer_load_dword v14, v3, s[48:51], s75 offen
    s_add_u32 s75, s75, 8192
    s_cmp_eq_u32 s44, 3
    s_cbranch_scc1 L_g_pfo
    buffer_load_dword v15, v3, s[48:51], s75 offen
    s_branch L_g_pfd
L_g_pfo:
    s_lshl_b32 s75, s74, 14
    buffer_load_dword v15, v3, s[52:55], s75 offen
    s_add_u32 s75, s75, 8192
    buffer_load_dword v14, v3, s[52:55], s75 offen
L_g_pfd:
    s_lshr_b32 s14, s33, 1
    s_lshl_b32 s14, s14, 7
    s_add_u32 s73, s14, 196608
    v_mov_b32 v3, s73
    s_mov_b64 exec, 1
    s_mov_b32 s35, 0
L_h_poll:
    global_load_dword v4, v3, s[28:29] sc1
    s_add_u32 s35, s35, 1
    s_waitcnt vmcnt(0)
    v_cmp_gt_u32 vcc, 16, v4
    s_cmp_ge_u32 s35, 200000
    s_cbranch_scc1 L_h_pdone
    s_nop 1
    s_cbranch_vccz L_h_pdone
    s_sleep 16
    s_branch L_h_poll
L_h_pdone:
    s_mov_b64 exec, -1
    v_mov_b32 v3, 162356
    s_mov_b32 s71, 0
L_g_qr:
    ds_read_b32 v4, v3
    s_add_u32 s71, s71, 1
    s_waitcnt lgkmcnt(0)
    v_cmp_gt_u32 vcc, 8, v4
    s_cmp_ge_u32 s71, 800000
    s_cbranch_scc1 L_g_qr2
    s_nop 1
    s_cbranch_vccnz L_g_qr
L_g_qr2:
    s_add_u32 m0, s46, 0
    s_nop 0
    buffer_load_dwordx4 v5, s[48:51], s64 offen lds
    s_add_u32 m0, s46, 1024
    s_nop 0
    buffer_load_dwordx4 v8, s[48:51], s64 offen lds
    s_add_u32 s64, s64, 16384
    buffer_load_dwordx4 v[16:19], v10, s[40:43], s65 offen sc1
    buffer_load_dwordx4 v[20:23], v9, s[40:43], s65 offen sc1
    s_add_u32 s65, s65, 1024
    s_add_u32 m0, s46, 2048
    s_nop 0
    buffer_load_dwordx4 v5, s[48:51], s64 offen lds
    s_add_u32 m0, s46, 3072
    s_nop 0
    buffer_load_dwordx4 v8, s[48:51], s64 offen lds
    s_add_u32 s64, s64, 16384
    buffer_load_dwordx4 v[24:27], v10, s[40:43], s65 offen sc1
    buffer_load_dwordx4 v[28:31], v9, s[40:43], s65 offen sc1
    s_add_u32 s65, s65, 1024
    s_add_u32 m0, s46, 4096
    s_nop 0
    buffer_load_dwordx4 v5, s[48:51], s64 offen lds
    s_add_u32 m0, s46, 5120
    s_nop 0
    buffer_load_dwordx4 v8, s[48:51], s64 offen lds
    s_add_u32 s64, s64, 16384
    buffer_load_dwordx4 v[32:35], v10, s[40:43], s65 offen sc1
    buffer_load_dwordx4 v[36:39], v9, s[40:43], s65 offen sc1
    s_add_u32 s65, s65, 1024
    s_waitcnt vmcnt(8)
    ds_read_b64_tr_b16 v[40:41], v6 offset:0
    ds_read_b64_tr_b16 v[42:43], v6 offset:512
    ds_read_b64_tr_b16 v[44:45], v7 offset:0
    ds_read_b64_tr_b16 v[46:47], v7 offset:512
    s_waitcnt lgkmcnt(0)
    v_mfma_f32_32x32x16_bf16 v[64:79], v[40:43], v[16:19], 0
    s_add_u32 m0, s46, 0
    s_nop 0
    buffer_load_dwordx4 v5, s[48:51], s64 offen lds
    s_add_u32 m0, s46, 1024
    s_nop 0
    buffer_load_dwordx4 v8, s[48:51], s64 offen lds
    s_add_u32 s64, s64, 16384
    v_mfma_f32_32x32x16_bf16 v[80:95], v[44:47], v[16:19], 0
    buffer_load_dwordx4 v[16:19], v10, s[40:43], s65 offen sc1
    s_waitcnt vmcnt(7)
    v_mfma_f32_32x32x16_bf16 v[96:111], v[40:43], v[20:23], 0
    ds_read_b64_tr_b16 v[48:49], v6 offset:2048
    ds_read_b64_tr_b16 v[50:51], v6 offset:2560
    ds_read_b64_tr_b16 v[52:53], v7 offset:2048
    ds_read_b64_tr_b16 v[54:55], v7 offset:2560
    v_mfma_f32_32x32x16_bf16 v[112:127], v[44:47], v[20:23], 0
    buffer_load_dwordx4 v[20:23], v9, s[40:43], s65 offen sc1
    s_add_u32 s65, s65, 1024
    s_mov_b32 s71, 0
L_d_loop:
    s_waitcnt lgkmcnt(0)
    v_mfma_f32_32x32x16_bf16 v[64:79], v[48:51], v[24:27], v[64:79]
    s_add_u32 m0, s46, 2048
    s_nop 0
    buffer_load_dwordx4 v5, s[48:51], s64 offen lds
    s_add_u32 m0, s46, 3072
    s_nop 0
    buffer_load_dwordx4 v8, s[48:51], s64 offen lds
    s_add_u32 s64, s64, 16384
    v_mfma_f32_32x32x16_bf16 v[80:95], v[52:55], v[24:27], v[80:95]
    buffer_load_dwordx4 v[24:27], v10, s[40:43], s65 offen sc1
    s_waitcnt vmcnt(7)
    v_mfma_f32_32x32x16_bf16 v[96:111], v[48:51], v[28:31], v[96:111]
    ds_read_b64_tr_b16 v[40:41], v6 offset:4096
    ds_read_b64_tr_b16 v[42:43], v6 offset:4608
    ds_read_b64_tr_b16 v[44:45], v7 offset:4096
    ds_read_b64_tr_b16 v[46:47], v7 offset:4608
    v_mfma_f32_32x32x16_bf16 v[112:127], v[52:55], v[28:31], v[112:127]
    buffer_load_dwordx4 v[28:31], v9, s[40:43], s65 offen sc1
    s_add_u32 s65, s65, 1024
    s_waitcnt lgkmcnt(0)
    v_mfma_f32_32x32x16_bf16 v[64:79], v[40:43], v[32:35], v[64:79]
    s_add_u32 m0, s46, 4096
    s_nop 0
    buffer_load_dwordx4 v5, s[48:51], s64 offen lds
    s_add_u32 m0, s46, 5120
    s_nop 0
    buffer_load_dwordx4 v8, s[48:51], s64 offen lds
    s_add_u32 s64, s64, 16384
    v_mfma_f32_32x32x16_bf16 v[80:95], v[44:47], v[32:35], v[80:95]
    buffer_load_dwordx4 v[32:35], v10, s[40:43], s65 offen sc1
    s_waitcnt vmcnt(7)
    v_mfma_f32_32x32x16_bf16 v[96:111], v[40:43], v[36:39], v[96:111]
    ds_read_b64_tr_b16 v[48:49], v6 offset:0
    ds_read_b64_tr_b16 v[50:51], v6 offset:512
    ds_read_b64_tr_b16 v[52:53], v7 offset:0
    ds_read_b64_tr_b16 v[54:55], v7 offset:512
    v_mfma_f32_32x32x16_bf16 v[112:127], v[44:47], v[36:39], v[112:127]
    buffer_load_dwordx4 v[36:39], v9, s[40:43], s65 offen sc1
    s_add_u32 s65, s65, 1024
    s_waitcnt lgkmcnt(0)
    v_mfma_f32_32x32x16_bf16 v[64:79], v[48:51], v[16:19], v[64:79]
    s_add_u32 m0, s46, 0
    s_nop 0
    buffer_load_dwordx4 v5, s[48:51], s64 offen lds
    s_add_u32 m0, s46, 1024
    s_nop 0
    buffer_load_dwordx4 v8, s[48:51], s64 offen lds
    s_add_u32 s64, s64, 16384
    v_mfma_f32_32x32x16_bf16 v[80:95], v[52:55], v[16:19], v[80:95]
    buffer_load_dwordx4 v[16:19], v10, s[40:43], s65 offen sc1
    s_waitcnt vmcnt(7)
    v_mfma_f32_32x32x16_bf16 v[96:111], v[48:51], v[20:23], v[96:111]
    ds_read_b64_tr_b16 v[40:41], v6 offset:2048
    ds_read_b64_tr_b16 v[42:43], v6 offset:2560
    ds_read_b64_tr_b16 v[44:45], v7 offset:2048
    ds_read_b64_tr_b16 v[46:47], v7 offset:2560
    v_mfma_f32_32x32x16_bf16 v[112:127], v[52:55], v[20:23], v[112:127]
    buffer_load_dwordx4 v[20:23], v9, s[40:43], s65 offen sc1
    s_add_u32 s65, s65, 1024
    s_waitcnt lgkmcnt(0)
    v_mfma_f32_32x32x16_bf16 v[64:79], v[40:43], v[24:27], v[64:79]
    s_add_u32 m0, s46, 2048
    s_nop 0
    buffer_load_dwordx4 v5, s[48:51], s64 offen lds
    s_add_u32 m0, s46, 3072
    s_nop 0
    buffer_load_dwordx4 v8, s[48:51], s64 offen lds
    s_add_u32 s64, s64, 16384
    v_mfma_f32_32x32x16_bf16 v[80:95], v[44:47], v[24:27], v[80:95]
    buffer_load_dwordx4 v[24:27], v10, s[40:43], s65 offen sc1
    s_waitcnt vmcnt(7)
    v_mfma_f32_32x32x16_bf16 v[96:111], v[40:43], v[28:31], v[96:111]
    ds_read_b64_tr_b16 v[48:49], v6 offset:4096
    ds_read_b64_tr_b16 v[50:51], v6 offset:4608
    ds_read_b64_tr_b16 v[52:53], v7 offset:4096
    ds_read_b64_tr_b16 v[54:55], v7 offset:4608
    v_mfma_f32_32x32x16_bf16 v[112:127], v[44:47], v[28:31], v[112:127]
    buffer_load_dwordx4 v[28:31], v9, s[40:43], s65 offen sc1
    s_add_u32 s65, s65, 1024
    s_waitcnt lgkmcnt(0)
    v_mfma_f32_32x32x16_bf16 v[64:79], v[48:51], v[32:35], v[64:79]
    s_add_u32 m0, s46, 4096
    s_nop 0
    buffer_load_dwordx4 v5, s[48:51], s64 offen lds
    s_add_u32 m0, s46, 5120
    s_nop 0
    buffer_load_dwordx4 v8, s[48:51], s64 offen lds
    s_add_u32 s64, s64, 16384
    v_mfma_f32_32x32x16_bf16 v[80:95], v[52:55], v[32:35], v[80:95]
    buffer_load_dwordx4 v[32:35], v10, s[40:43], s65 offen sc1
    s_waitcnt vmcnt(7)
    v_mfma_f32_32x32x16_bf16 v[96:111], v[48:51], v[36:39], v[96:111]
    ds_read_b64_tr_b16 v[40:41], v6 offset:0
    ds_read_b64_tr_b16 v[42:43], v6 offset:512
    ds_read_b64_tr_b16 v[44:45], v7 offset:0
    ds_read_b64_tr_b16 v[46:47], v7 offset:512
    v_mfma_f32_32x32x16_bf16 v[112:127], v[52:55], v[36:39], v[112:127]
    buffer_load_dwordx4 v[36:39], v9, s[40:43], s65 offen sc1
    s_add_u32 s65, s65, 1024
    s_waitcnt lgkmcnt(0)
    v_mfma_f32_32x32x16_bf16 v[64:79], v[40:43], v[16:19], v[64:79]
    s_add_u32 m0, s46, 0
    s_nop 0
    buffer_load_dwordx4 v5, s[48:51], s64 offen lds
    s_add_u32 m0, s46, 1024
    s_nop 0
    buffer_load_dwordx4 v8, s[48:51], s64 offen lds
    s_add_u32 s64, s64, 16384
    v_mfma_f32_32x32x16_bf16 v[80:95], v[44:47], v[16:19], v[80:95]
    buffer_load_dwordx4 v[16:19], v10, s[40:43], s65 offen sc1
    s_waitcnt vmcnt(7)
    v_mfma_f32_32x32x16_bf16 v[96:111], v[40:43], v[20:23], v[96:111]
    ds_read_b64_tr_b16 v[48:49], v6 offset:2048
    ds_read_b64_tr_b16 v[50:51], v6 offset:2560
    ds_read_b64_tr_b16 v[52:53], v7 offset:2048
    ds_read_b64_tr_b16 v[54:55], v7 offset:2560
    v_mfma_f32_32x32x16_bf16 v[112:127], v[44:47], v[20:23], v[112:127]
    buffer_load_dwordx4 v[20:23], v9, s[40:43], s65 offen sc1
    s_add_u32 s65, s65, 1024
    s_add_u32 s71, s71, 1
    s_cmp_lt_u32 s71, 4
    s_cbranch_scc1 L_d_loop
    s_waitcnt lgkmcnt(0)
    v_mfma_f32_32x32x16_bf16 v[64:79], v[48:51], v[24:27], v[64:79]
    v_mfma_f32_32x32x16_bf16 v[80:95], v[52:55], v[24:27], v[80:95]
    s_waitcnt vmcnt(4)
    v_mfma_f32_32x32x16_bf16 v[96:111], v[48:51], v[28:31], v[96:111]
    ds_read_b64_tr_b16 v[40:41], v6 offset:4096
    ds_read_b64_tr_b16 v[42:43], v6 offset:4608
    ds_read_b64_tr_b16 v[44:45], v7 offset:4096
    ds_read_b64_tr_b16 v[46:47], v7 offset:4608
    v_mfma_f32_32x32x16_bf16 v[112:127], v[52:55], v[28:31], v[112:127]
    s_waitcnt lgkmcnt(0)
    v_mfma_f32_32x32x16_bf16 v[64:79], v[40:43], v[32:35], v[64:79]
    v_mfma_f32_32x32x16_bf16 v[80:95], v[44:47], v[32:35], v[80:95]
    s_waitcnt vmcnt(0)
    v_mfma_f32_32x32x16_bf16 v[96:111], v[40:43], v[36:39], v[96:111]
    ds_read_b64_tr_b16 v[48:49], v6 offset:0
    ds_read_b64_tr_b16 v[50:51], v6 offset:512
    ds_read_b64_tr_b16 v[52:53], v7 offset:0
    ds_read_b64_tr_b16 v[54:55], v7 offset:512
    v_mfma_f32_32x32x16_bf16 v[112:127], v[44:47], v[36:39], v[112:127]
    s_waitcnt lgkmcnt(0)
    v_mfma_f32_32x32x16_bf16 v[64:79], v[48:51], v[16:19], v[64:79]
    v_mfma_f32_32x32x16_bf16 v[80:95], v[52:55], v[16:19], v[80:95]
    v_mfma_f32_32x32x16_bf16 v[96:111], v[48:51], v[20:23], v[96:111]
    v_mfma_f32_32x32x16_bf16 v[112:127], v[52:55], v[20:23], v[112:127]
    s_mul_i32 s64, s44, 131072
    s_add_u32 m0, s46, 0
    s_nop 0
    buffer_load_dwordx4 v5, s[52:55], s64 offen lds
    s_add_u32 m0, s46, 1024
    s_nop 0
    buffer_load_dwordx4 v8, s[52:55], s64 offen lds
    s_add_u32 s64, s64, 16384
    s_add_u32 m0, s46, 2048
    s_nop 0
    buffer_load_dwordx4 v5, s[52:55], s64 offen lds
    s_add_u32 m0, s46, 3072
    s_nop 0
    buffer_load_dwordx4 v8, s[52:55], s64 offen lds
    s_add_u32 s64, s64, 16384
    s_add_u32 m0, s46, 4096
    s_nop 0
    buffer_load_dwordx4 v5, s[52:55], s64 offen lds
    s_add_u32 m0, s46, 5120
    s_nop 0
    buffer_load_dwordx4 v8, s[52:55], s64 offen lds
    s_add_u32 s64, s64, 16384
    v_sub_f32 v12, 1.0, v12
    v_sub_f32 v13, 1.0, v13
    s_nop 7
    v_pk_mul_f32 v[64:65], v[64:65], v[12:13] op_sel:[0,0] op_sel_hi:[1,0]
    v_pk_mul_f32 v[66:67], v[66:67], v[12:13] op_sel:[0,0] op_sel_hi:[1,0]
    v_pk_mul_f32 v[68:69], v[68:69], v[12:13] op_sel:[0,0] op_sel_hi:[1,0]
    v_pk_mul_f32 v[70:71], v[70:71], v[12:13] op_sel:[0,0] op_sel_hi:[1,0]
    v_pk_mul_f32 v[72:73], v[72:73], v[12:13] op_sel:[0,0] op_sel_hi:[1,0]
    v_pk_mul_f32 v[74:75], v[74:75], v[12:13] op_sel:[0,0] op_sel_hi:[1,0]
    v_pk_mul_f32 v[76:77], v[76:77], v[12:13] op_sel:[0,0] op_sel_hi:[1,0]
    v_pk_mul_f32 v[78:79], v[78:79], v[12:13] op_sel:[0,0] op_sel_hi:[1,0]
    v_pk_mul_f32 v[80:81], v[80:81], v[12:13] op_sel:[0,0] op_sel_hi:[1,0]
    v_pk_mul_f32 v[82:83], v[82:83], v[12:13] op_sel:[0,0] op_sel_hi:[1,0]
    v_pk_mul_f32 v[84:85], v[84:85], v[12:13] op_sel:[0,0] op_sel_hi:[1,0]
    v_pk_mul_f32 v[86:87], v[86:87], v[12:13] op_sel:[0,0] op_sel_hi:[1,0]
    v_pk_mul_f32 v[88:89], v[88:89], v[12:13] op_sel:[0,0] op_sel_hi:[1,0]
    v_pk_mul_f32 v[90:91], v[90:91], v[12:13] op_sel:[0,0] op_sel_hi:[1,0]
    v_pk_mul_f32 v[92:93], v[92:93], v[12:13] op_sel:[0,0] op_sel_hi:[1,0]
    v_pk_mul_f32 v[94:95], v[94:95], v[12:13] op_sel:[0,0] op_sel_hi:[1,0]
    v_pk_mul_f32 v[96:97], v[96:97], v[12:13] op_sel:[0,1] op_sel_hi:[1,1]
    v_pk_mul_f32 v[98:99], v[98:99], v[12:13] op_sel:[0,1] op_sel_hi:[1,1]
    v_pk_mul_f32 v[100:101], v[100:101], v[12:13] op_sel:[0,1] op_sel_hi:[1,1]
    v_pk_mul_f32 v[102:103], v[102:103], v[12:13] op_sel:[0,1] op_sel_hi:[1,1]
    v_pk_mul_f32 v[104:105], v[104:105], v[12:13] op_sel:[0,1] op_sel_hi:[1,1]
    v_pk_mul_f32 v[106:107], v[106:107], v[12:13] op_sel:[0,1] op_sel_hi:[1,1]
    v_pk_mul_f32 v[108:109], v[108:109], v[12:13] op_sel:[0,1] op_sel_hi:[1,1]
    v_pk_mul_f32 v[110:111], v[110:111], v[12:13] op_sel:[0,1] op_sel_hi:[1,1]
    v_pk_mul_f32 v[112:113], v[112:113], v[12:13] op_sel:[0,1] op_sel_hi:[1,1]
    v_pk_mul_f32 v[114:115], v[114:115], v[12:13] op_sel:[0,1] op_sel_hi:[1,1]
    v_pk_mul_f32 v[116:117], v[116:117], v[12:13] op_sel:[0,1] op_sel_hi:[1,1]
    v_pk_mul_f32 v[118:119], v[118:119], v[12:13] op_sel:[0,1] op_sel_hi:[1,1]
    v_pk_mul_f32 v[120:121], v[120:121], v[12:13] op_sel:[0,1] op_sel_hi:[1,1]
    v_pk_mul_f32 v[122:123], v[122:123], v[12:13] op_sel:[0,1] op_sel_hi:[1,1]
    v_pk_mul_f32 v[124:125], v[124:125], v[12:13] op_sel:[0,1] op_sel_hi:[1,1]
    v_pk_mul_f32 v[126:127], v[126:127], v[12:13] op_sel:[0,1] op_sel_hi:[1,1]
    s_waitcnt vmcnt(4)
    ds_read_b64_tr_b16 v[128:129], v6 offset:0
    ds_read_b64_tr_b16 v[130:131], v6 offset:512
    ds_read_b64_tr_b16 v[132:133], v7 offset:0
    ds_read_b64_tr_b16 v[134:135], v7 offset:512
    s_waitcnt lgkmcnt(0)
    s_add_u32 m0, s46, 0
    s_nop 0
    buffer_load_dwordx4 v5, s[52:55], s64 offen lds
    s_add_u32 m0, s46, 1024
    s_nop 0
    buffer_load_dwordx4 v8, s[52:55], s64 offen lds
    s_add_u32 s64, s64, 16384
    s_waitcnt vmcnt(4)
    ds_read_b64_tr_b16 v[136:137], v6 offset:2048
    ds_read_b64_tr_b16 v[138:139], v6 offset:2560
    ds_read_b64_tr_b16 v[140:141], v7 offset:2048
    ds_read_b64_tr_b16 v[142:143], v7 offset:2560
    s_waitcnt lgkmcnt(0)
    s_add_u32 m0, s46, 2048
    s_nop 0
    buffer_load_dwordx4 v5, s[52:55], s64 offen lds
    s_add_u32 m0, s46, 3072
    s_nop 0
    buffer_load_dwordx4 v8, s[52:55], s64 offen lds
    s_add_u32 s64, s64, 16384
    s_waitcnt vmcnt(4)
    ds_read_b64_tr_b16 v[144:145], v6 offset:4096
    ds_read_b64_tr_b16 v[146:147], v6 offset:4608
    ds_read_b64_tr_b16 v[148:149], v7 offset:4096
    ds_read_b64_tr_b16 v[150:151], v7 offset:4608
    s_waitcnt lgkmcnt(0)
    s_add_u32 m0, s46, 4096
    s_nop 0
    buffer_load_dwordx4 v5, s[52:55], s64 offen lds
    s_add_u32 m0, s46, 5120
    s_nop 0
    buffer_load_dwordx4 v8, s[52:55], s64 offen lds
    s_add_u32 s64, s64, 16384
    s_waitcnt vmcnt(4)
    ds_read_b64_tr_b16 v[152:153], v6 offset:0
    ds_read_b64_tr_b16 v[154:155], v6 offset:512
    ds_read_b64_tr_b16 v[156:157], v7 offset:0
    ds_read_b64_tr_b16 v[158:159], v7 offset:512
    s_waitcnt lgkmcnt(0)
    s_add_u32 m0, s46, 0
    s_nop 0
    buffer_load_dwordx4 v5, s[52:55], s64 offen lds
    s_add_u32 m0, s46, 1024
    s_nop 0
    buffer_load_dwordx4 v8, s[52:55], s64 offen lds
    s_add_u32 s64, s64, 16384
    s_waitcnt vmcnt(4)
    ds_read_b64_tr_b16 v[16:17], v6 offset:2048
    ds_read_b64_tr_b16 v[18:19], v6 offset:2560
    ds_read_b64_tr_b16 v[20:21], v7 offset:2048
    ds_read_b64_tr_b16 v[22:23], v7 offset:2560
    s_waitcnt lgkmcnt(0)
    s_add_u32 m0, s46, 2048
    s_nop 0
    buffer_load_dwordx4 v5, s[52:55], s64 offen lds
    s_add_u32 m0, s46, 3072
    s_nop 0
    buffer_load_dwordx4 v8, s[52:55], s64 offen lds
    s_add_u32 s64, s64, 16384
    s_waitcnt vmcnt(4)
    ds_read_b64_tr_b16 v[24:25], v6 offset:4096
    ds_read_b64_tr_b16 v[26:27], v6 offset:4608
    ds_read_b64_tr_b16 v[28:29], v7 offset:4096
    ds_read_b64_tr_b16 v[30:31], v7 offset:4608
    s_waitcnt lgkmcnt(0)
    s_waitcnt vmcnt(2)
    ds_read_b64_tr_b16 v[32:33], v6 offset:0
    ds_read_b64_tr_b16 v[34:35], v6 offset:512
    ds_read_b64_tr_b16 v[36:37], v7 offset:0
    ds_read_b64_tr_b16 v[38:39], v7 offset:512
    s_waitcnt lgkmcnt(0)
    s_waitcnt vmcnt(0)
    ds_read_b64_tr_b16 v[40:41], v6 offset:2048
    ds_read_b64_tr_b16 v[42:43], v6 offset:2560
    ds_read_b64_tr_b16 v[44:45], v7 offset:2048
    ds_read_b64_tr_b16 v[46:47], v7 offset:2560
    s_waitcnt lgkmcnt(0)
    v_mov_b32 v3, 162352
    v_mov_b32 v4, 1
    s_mov_b64 exec, 1
    ds_add_u32 v3, v4
    s_lshl_b32 s15, s44, 3
    s_add_u32 s65, s72, s15
    s_add_u32 s65, s65, 112
    s_lshl_b32 s65, s65, 10
    s_add_u32 s65, s65, 4194304
    s_add_u32 s66, s65, 4096
    s_mov_b64 exec, -1
    v_lshrrev_b32 v3, 1, v1
    v_lshlrev_b32 v3, 11, v3
    v_and_b32 v4, 1, v1
    v_mul_u32_u24 v4, 147456, v4
    v_add_u32 v3, v3, v4
    v_add_u32 v3, 2044, v3
    s_lshl_b32 s72, s44, 14
    v_add_u32 v161, s72, v2
    s_lshl_b32 s14, s44, 2
    s_add_u32 s14, s14, 162320
    v_mov_b32 v5, s14
    v_mov_b32 v8, 162376
    s_mov_b32 s71, 0
    s_mov_b64 exec, 0xff
L_g_cd:
    ds_read_b32 v4, v5
    s_add_u32 s71, s71, 1
    s_waitcnt lgkmcnt(0)
    v_cmp_gt_u32 vcc, 1, v4
    s_cmp_ge_u32 s71, 200000
    s_cbranch_scc1 L_g_cd2
    s_sleep 4
    s_cbranch_vccnz L_g_cd
L_g_cd2:
    s_mov_b32 s71, 0
L_o_probe:
    buffer_load_dword v4, v3, s[40:43], s65 offen sc1
    s_add_u32 s71, s71, 1
    s_waitcnt vmcnt(0)
    v_cmp_eq_u32 vcc, -1, v4
    s_cmp_ge_u32 s71, 200000
    s_cbranch_scc1 L_o_kf
    s_nop 0
    s_cbranch_vccnz L_o_probe
L_o_kf:
    ds_read_b32 v4, v8
    s_add_u32 s71, s71, 1
    s_waitcnt lgkmcnt(0)
    v_cmp_gt_u32 vcc, 8, v4
    s_cmp_ge_u32 s71, 1600000
    s_cbranch_scc1 L_o_go
    s_sleep 1
    s_cbranch_vccnz L_o_kf
L_o_go:
    s_mov_b64 exec, -1
    s_add_u32 m0, s72, 0
    s_nop 0
    buffer_load_dwordx4 v10, s[40:43], s65 offen offset:0 sc1 lds
    s_add_u32 m0, s72, 1024
    s_nop 0
    buffer_load_dwordx4 v9, s[40:43], s65 offen offset:0 sc1 lds
    s_add_u32 m0, s72, 1024
    s_nop 0
    buffer_load_dwordx4 v10, s[40:43], s65 offen offset:1024 sc1 lds
    s_add_u32 m0, s72, 2048
    s_nop 0
    buffer_load_dwordx4 v9, s[40:43], s65 offen offset:1024 sc1 lds
    s_add_u32 m0, s72, 2048
    s_nop 0
    buffer_load_dwordx4 v10, s[40:43], s65 offen offset:2048 sc1 lds
    s_add_u32 m0, s72, 3072
    s_nop 0
    buffer_load_dwordx4 v9, s[40:43], s65 offen offset:2048 sc1 lds
    s_add_u32 m0, s72, 3072
    s_nop 0
    buffer_load_dwordx4 v10, s[40:43], s65 offen offset:3072 sc1 lds
    s_add_u32 m0, s72, 4096
    s_nop 0
    buffer_load_dwordx4 v9, s[40:43], s65 offen offset:3072 sc1 lds
    s_add_u32 m0, s72, 8192
    s_nop 0
    buffer_load_dwordx4 v10, s[40:43], s66 offen offset:0 sc1 lds
    s_add_u32 m0, s72, 9216
    s_nop 0
    buffer_load_dwordx4 v9, s[40:43], s66 offen offset:0 sc1 lds
    s_add_u32 m0, s72, 9216
    s_nop 0
    buffer_load_dwordx4 v10, s[40:43], s66 offen offset:1024 sc1 lds
    s_add_u32 m0, s72, 10240
    s_nop 0
    buffer_load_dwordx4 v9, s[40:43], s66 offen offset:1024 sc1 lds
    s_add_u32 m0, s72, 10240
    s_nop 0
    buffer_load_dwordx4 v10, s[40:43], s66 offen offset:2048 sc1 lds
    s_add_u32 m0, s72, 11264
    s_nop 0
    buffer_load_dwordx4 v9, s[40:43], s66 offen offset:2048 sc1 lds
    s_add_u32 m0, s72, 11264
    s_nop 0
    buffer_load_dwordx4 v10, s[40:43], s66 offen offset:3072 sc1 lds
    s_add_u32 m0, s72, 12288
    s_nop 0
    buffer_load_dwordx4 v9, s[40:43], s66 offen offset:3072 sc1 lds
    s_waitcnt vmcnt(14)
    ds_read_b128 v[48:51], v161 offset:0
    ds_read_b128 v[52:55], v161 offset:1024
    s_waitcnt vmcnt(12)
    ds_read_b128 v[56:59], v161 offset:2048
    ds_read_b128 v[60:63], v161 offset:3072
    s_waitcnt lgkmcnt(2)
L_o_chk0:
    v_max3_u32 v3, v48, v49, v50
    v_max3_u32 v4, v51, v52, v53
    v_max3_u32 v3, v3, v54, v55
    v_max_u32 v3, v3, v4
    v_cmp_eq_u32 vcc, -1, v3
    s_nop 1
    s_cbranch_vccnz L_o_bad0
L_o_ok0:
    v_mfma_f32_32x32x16_bf16 v[64:79], v[128:131], v[48:51], v[64:79]
    v_mfma_f32_32x32x16_bf16 v[80:95], v[132:135], v[48:51], v[80:95]
    v_mfma_f32_32x32x16_bf16 v[96:111], v[128:131], v[52:55], v[96:111]
    v_mfma_f32_32x32x16_bf16 v[112:127], v[132:135], v[52:55], v[112:127]
    s_waitcnt vmcnt(10)
    ds_read_b128 v[48:51], v161 offset:4096
    ds_read_b128 v[52:55], v161 offset:5120
    s_waitcnt lgkmcnt(2)
L_o_chk1:
    v_max3_u32 v3, v56, v57, v58
    v_max3_u32 v4, v59, v60, v61
    v_max3_u32 v3, v3, v62, v63
    v_max_u32 v3, v3, v4
    v_cmp_eq_u32 vcc, -1, v3
    s_nop 1
    s_cbranch_vccnz L_o_bad1
L_o_ok1:
    v_mfma_f32_32x32x16_bf16 v[64:79], v[136:139], v[56:59], v[64:79]
    v_mfma_f32_32x32x16_bf16 v[80:95], v[140:143], v[56:59], v[80:95]
    v_mfma_f32_32x32x16_bf16 v[96:111], v[136:139], v[60:63], v[96:111]
    v_mfma_f32_32x32x16_bf16 v[112:127], v[140:143], v[60:63], v[112:127]
    s_waitcnt vmcnt(8)
    ds_read_b128 v[56:59], v161 offset:6144
    ds_read_b128 v[60:63], v161 offset:7168
    s_waitcnt lgkmcnt(2)
L_o_chk2:
    v_max3_u32 v3, v48, v49, v50
    v_max3_u32 v4, v51, v52, v53
    v_max3_u32 v3, v3, v54, v55
    v_max_u32 v3, v3, v4
    v_cmp_eq_u32 vcc, -1, v3
    s_nop 1
    s_cbranch_vccnz L_o_bad2
L_o_ok2:
    v_mfma_f32_32x32x16_bf16 v[64:79], v[144:147], v[48:51], v[64:79]
    v_mfma_f32_32x32x16_bf16 v[80:95], v[148:151], v[48:51], v[80:95]
    v_mfma_f32_32x32x16_bf16 v[96:111], v[144:147], v[52:55], v[96:111]
    v_mfma_f32_32x32x16_bf16 v[112:127], v[148:151], v[52:55], v[112:127]
    s_waitcnt vmcnt(6)
    ds_read_b128 v[48:51], v161 offset:8192
    ds_read_b128 v[52:55], v161 offset:9216
    s_waitcnt lgkmcnt(2)
L_o_chk3:
    v_max3_u32 v3, v56, v57, v58
    v_max3_u32 v4, v59, v60, v61
    v_max3_u32 v3, v3, v62, v63
    v_max_u32 v3, v3, v4
    v_cmp_eq_u32 vcc, -1, v3
    s_nop 1
    s_cbranch_vccnz L_o_bad3
L_o_ok3:
    v_mfma_f32_32x32x16_bf16 v[64:79], v[152:155], v[56:59], v[64:79]
    v_mfma_f32_32x32x16_bf16 v[80:95], v[156:159], v[56:59], v[80:95]
    v_mfma_f32_32x32x16_bf16 v[96:111], v[152:155], v[60:63], v[96:111]
    v_mfma_f32_32x32x16_bf16 v[112:127], v[156:159], v[60:63], v[112:127]
    s_waitcnt vmcnt(4)
    ds_read_b128 v[56:59], v161 offset:10240
    ds_read_b128 v[60:63], v161 offset:11264
    s_waitcnt lgkmcnt(2)
L_o_chk4:
    v_max3_u32 v3, v48, v49, v50
    v_max3_u32 v4, v51, v52, v53
    v_max3_u32 v3, v3, v54, v55
    v_max_u32 v3, v3, v4
    v_cmp_eq_u32 vcc, -1, v3
    s_nop 1
    s_cbranch_vccnz L_o_bad4
L_o_ok4:
    v_mfma_f32_32x32x16_bf16 v[64:79], v[16:19], v[48:51], v[64:79]
    v_mfma_f32_32x32x16_bf16 v[80:95], v[20:23], v[48:51], v[80:95]
    v_mfma_f32_32x32x16_bf16 v[96:111], v[16:19], v[52:55], v[96:111]
    v_mfma_f32_32x32x16_bf16 v[112:127], v[20:23], v[52:55], v[112:127]
    s_waitcnt vmcnt(2)
    ds_read_b128 v[48:51], v161 offset:12288
    ds_read_b128 v[52:55], v161 offset:13312
    s_waitcnt lgkmcnt(2)
L_o_chk5:
    v_max3_u32 v3, v56, v57, v58
    v_max3_u32 v4, v59, v60, v61
    v_max3_u32 v3, v3, v62, v63
    v_max_u32 v3, v3, v4
    v_cmp_eq_u32 vcc, -1, v3
    s_nop 1
    s_cbranch_vccnz L_o_bad5
L_o_ok5:
    v_mfma_f32_32x32x16_bf16 v[64:79], v[24:27], v[56:59], v[64:79]
    v_mfma_f32_32x32x16_bf16 v[80:95], v[28:31], v[56:59], v[80:95]
    v_mfma_f32_32x32x16_bf16 v[96:111], v[24:27], v[60:63], v[96:111]
    v_mfma_f32_32x32x16_bf16 v[112:127], v[28:31], v[60:63], v[112:127]
    s_waitcnt vmcnt(0)
    ds_read_b128 v[56:59], v161 offset:14336
    ds_read_b128 v[60:63], v161 offset:15360
    s_waitcnt lgkmcnt(2)
L_o_chk6:
    v_max3_u32 v3, v48, v49, v50
    v_max3_u32 v4, v51, v52, v53
    v_max3_u32 v3, v3, v54, v55
    v_max_u32 v3, v3, v4
    v_cmp_eq_u32 vcc, -1, v3
    s_nop 1
    s_cbranch_vccnz L_o_bad6
L_o_ok6:
    v_mfma_f32_32x32x16_bf16 v[64:79], v[32:35], v[48:51], v[64:79]
    v_mfma_f32_32x32x16_bf16 v[80:95], v[36:39], v[48:51], v[80:95]
    v_mfma_f32_32x32x16_bf16 v[96:111], v[32:35], v[52:55], v[96:111]
    v_mfma_f32_32x32x16_bf16 v[112:127], v[36:39], v[52:55], v[112:127]
    s_waitcnt lgkmcnt(0)
L_o_chk7:
    v_max3_u32 v3, v56, v57, v58
    v_max3_u32 v4, v59, v60, v61
    v_max3_u32 v3, v3, v62, v63
    v_max_u32 v3, v3, v4
    v_cmp_eq_u32 vcc, -1, v3
    s_nop 1
    s_cbranch_vccnz L_o_bad7
L_o_ok7:
    v_mfma_f32_32x32x16_bf16 v[64:79], v[40:43], v[56:59], v[64:79]
    v_mfma_f32_32x32x16_bf16 v[80:95], v[44:47], v[56:59], v[80:95]
    v_mfma_f32_32x32x16_bf16 v[96:111], v[40:43], v[60:63], v[96:111]
    v_mfma_f32_32x32x16_bf16 v[112:127], v[44:47], v[60:63], v[112:127]
    s_branch L_o_done
L_o_bad0:
    s_add_u32 s71, s71, 1
    s_cmp_ge_u32 s71, 200000
    s_cbranch_scc1 L_o_ok0
    buffer_load_dwordx4 v[48:51], v10, s[40:43], s65 offen offset:0 sc1
    buffer_load_dwordx4 v[52:55], v9, s[40:43], s65 offen offset:0 sc1
    s_waitcnt vmcnt(0)
    s_branch L_o_chk0
L_o_bad1:
    s_add_u32 s71, s71, 1
    s_cmp_ge_u32 s71, 200000
    s_cbranch_scc1 L_o_ok1
    buffer_load_dwordx4 v[56:59], v10, s[40:43], s65 offen offset:1024 sc1
    buffer_load_dwordx4 v[60:63], v9, s[40:43], s65 offen offset:1024 sc1
    s_waitcnt vmcnt(0)
    s_branch L_o_chk1
L_o_bad2:
    s_add_u32 s71, s71, 1
    s_cmp_ge_u32 s71, 200000
    s_cbranch_scc1 L_o_ok2
    buffer_load_dwordx4 v[48:51], v10, s[40:43], s65 offen offset:2048 sc1
    buffer_load_dwordx4 v[52:55], v9, s[40:43], s65 offen offset:2048 sc1
    s_waitcnt vmcnt(0)
    s_branch L_o_chk2
L_o_bad3:
    s_add_u32 s71, s71, 1
    s_cmp_ge_u32 s71, 200000
    s_cbranch_scc1 L_o_ok3
    buffer_load_dwordx4 v[56:59], v10, s[40:43], s65 offen offset:3072 sc1
    buffer_load_dwordx4 v[60:63], v9, s[40:43], s65 offen offset:3072 sc1
    s_waitcnt vmcnt(0)
    s_branch L_o_chk3
L_o_bad4:
    s_add_u32 s71, s71, 1
    s_cmp_ge_u32 s71, 200000
    s_cbranch_scc1 L_o_ok4
    buffer_load_dwordx4 v[48:51], v10, s[40:43], s66 offen offset:0 sc1
    buffer_load_dwordx4 v[52:55], v9, s[40:43], s66 offen offset:0 sc1
    s_waitcnt vmcnt(0)
    s_branch L_o_chk4
L_o_bad5:
    s_add_u32 s71, s71, 1
    s_cmp_ge_u32 s71, 200000
    s_cbranch_scc1 L_o_ok5
    buffer_load_dwordx4 v[56:59], v10, s[40:43], s66 offen offset:1024 sc1
    buffer_load_dwordx4 v[60:63], v9, s[40:43], s66 offen offset:1024 sc1
    s_waitcnt vmcnt(0)
    s_branch L_o_chk5
L_o_bad6:
    s_add_u32 s71, s71, 1
    s_cmp_ge_u32 s71, 200000
    s_cbranch_scc1 L_o_ok6
    buffer_load_dwordx4 v[48:51], v10, s[40:43], s66 offen offset:2048 sc1
    buffer_load_dwordx4 v[52:55], v9, s[40:43], s66 offen offset:2048 sc1
    s_waitcnt vmcnt(0)
    s_branch L_o_chk6
L_o_bad7:
    s_add_u32 s71, s71, 1
    s_cmp_ge_u32 s71, 200000
    s_cbranch_scc1 L_o_ok7
    buffer_load_dwordx4 v[56:59], v10, s[40:43], s66 offen offset:3072 sc1
    buffer_load_dwordx4 v[60:63], v9, s[40:43], s66 offen offset:3072 sc1
    s_waitcnt vmcnt(0)
    s_branch L_o_chk7
L_o_done:
    s_xor_b32 s65, s44, 1
    s_mul_i32 s65, s65, 12288
    s_add_u32 s65, s65, 65536
    v_add_u32 v3, s65, v2
    s_xor_b32 s65, s44, 2
    s_mul_i32 s65, s65, 12288
    s_add_u32 s65, s65, 69632
    v_add_u32 v4, s65, v2
    s_xor_b32 s65, s44, 3
    s_mul_i32 s65, s65, 12288
    s_add_u32 s65, s65, 73728
    v_add_u32 v5, s65, v2
    s_mul_i32 s65, s44, 12288
    s_add_u32 s65, s65, 0x10000
    v_add_u32 v8, s65, v2
    s_nop 3
    ds_write_b128 v3, v[80:83] offset:0
    ds_write_b128 v3, v[84:87] offset:1024
    ds_write_b128 v3, v[88:91] offset:2048
    ds_write_b128 v3, v[92:95] offset:3072
    ds_write_b128 v4, v[96:99] offset:0
    ds_write_b128 v4, v[100:103] offset:1024
    ds_write_b128 v4, v[104:107] offset:2048
    ds_write_b128 v4, v[108:111] offset:3072
    ds_write_b128 v5, v[112:115] offset:0
    ds_write_b128 v5, v[116:119] offset:1024
    ds_write_b128 v5, v[120:123] offset:2048
    ds_write_b128 v5, v[124:127] offset:3072
    s_waitcnt lgkmcnt(0)
    s_barrier
    ds_read_b128 v[80:83], v8 offset:0
    ds_read_b128 v[84:87], v8 offset:1024
    ds_read_b128 v[88:91], v8 offset:2048
    ds_read_b128 v[92:95], v8 offset:3072
    ds_read_b128 v[96:99], v8 offset:4096
    ds_read_b128 v[100:103], v8 offset:5120
    ds_read_b128 v[104:107], v8 offset:6144
    ds_read_b128 v[108:111], v8 offset:7168
    ds_read_b128 v[112:115], v8 offset:8192
    ds_read_b128 v[116:119], v8 offset:9216
    ds_read_b128 v[120:123], v8 offset:10240
    ds_read_b128 v[124:127], v8 offset:11264
    s_lshr_b32 s65, s44, 1
    s_lshl_b32 s65, s65, 5
    s_lshl_b32 s14, s33, 6
    s_add_u32 s65, s65, s14
    s_lshl_b32 s65, s65, 10
    s_lshl_b32 s14, s34, 7
    s_add_u32 s65, s65, s14
    s_and_b32 s14, s44, 1
    s_lshl_b32 s14, s14, 6
    s_add_u32 s65, s65, s14
    v_and_b32 v3, 31, v1
    v_lshlrev_b32 v3, 10, v3
    v_lshrrev_b32 v4, 5, v1
    v_lshl_add_u32 v3, v4, 4, v3
    s_waitcnt lgkmcnt(0)
    v_pk_add_f32 v[80:81], v[80:81], v[96:97]
    v_pk_add_f32 v[64:65], v[64:65], v[112:113]
    v_pk_add_f32 v[82:83], v[82:83], v[98:99]
    v_pk_add_f32 v[66:67], v[66:67], v[114:115]
    v_pk_add_f32 v[84:85], v[84:85], v[100:101]
    v_pk_add_f32 v[68:69], v[68:69], v[116:117]
    v_pk_add_f32 v[86:87], v[86:87], v[102:103]
    v_pk_add_f32 v[70:71], v[70:71], v[118:119]
    v_pk_add_f32 v[88:89], v[88:89], v[104:105]
    v_pk_add_f32 v[72:73], v[72:73], v[120:121]
    v_pk_add_f32 v[90:91], v[90:91], v[106:107]
    v_pk_add_f32 v[74:75], v[74:75], v[122:123]
    v_pk_add_f32 v[92:93], v[92:93], v[108:109]
    v_pk_add_f32 v[76:77], v[76:77], v[124:125]
    v_pk_add_f32 v[94:95], v[94:95], v[110:111]
    v_pk_add_f32 v[78:79], v[78:79], v[126:127]
    v_pk_add_f32 v[64:65], v[64:65], v[80:81]
    v_pk_add_f32 v[66:67], v[66:67], v[82:83]
    v_pk_add_f32 v[68:69], v[68:69], v[84:85]
    v_pk_add_f32 v[70:71], v[70:71], v[86:87]
    v_pk_add_f32 v[72:73], v[72:73], v[88:89]
    v_pk_add_f32 v[74:75], v[74:75], v[90:91]
    v_pk_add_f32 v[76:77], v[76:77], v[92:93]
    v_pk_add_f32 v[78:79], v[78:79], v[94:95]
    v_cvt_pk_bf16_f32 v64, v64, v65
    v_cvt_pk_bf16_f32 v65, v66, v67
    v_cvt_pk_bf16_f32 v66, v68, v69
    v_cvt_pk_bf16_f32 v67, v70, v71
    v_cvt_pk_bf16_f32 v68, v72, v73
    v_cvt_pk_bf16_f32 v69, v74, v75
    v_cvt_pk_bf16_f32 v70, v76, v77
    v_cvt_pk_bf16_f32 v71, v78, v79
    buffer_store_dwordx4 v[64:67], v3, s[56:59], s65 offen
    buffer_store_dwordx4 v[68:71], v3, s[56:59], s65 offen offset:32
L_exit:
    s_endpgm
L_code_end:
.section .rodata,"a"
.p2align 6
.amdhsa_kernel gated_mix__grouped_kv_mqa__glu_gated_bilinear__prompt_kernel
  .amdhsa_next_free_vgpr 168
  .amdhsa_next_free_sgpr 102
  .amdhsa_accum_offset 168
  .amdhsa_group_segment_fixed_size 0
  .amdhsa_kernarg_size 104
  .amdhsa_user_sgpr_count 2
  .amdhsa_user_sgpr_kernarg_segment_ptr 1
  .amdhsa_system_sgpr_workgroup_id_x 1
.end_amdhsa_kernel
```
